```python
import torch

def _softmax(x, axis=-1):
    return torch.softmax(x, dim=axis)
def _gelu(x):
    return torch.nn.functional.gelu(x, approximate="tanh")
def _silu(x):
    return torch.nn.functional.silu(x)
def _sigmoid(x):
    return torch.sigmoid(x)
def _layernorm(x, axis=-1, eps=1e-5):
    m = x.mean(dim=axis, keepdim=True)
    v = x.var(dim=axis, keepdim=True, unbiased=False)
    return (x - m) / torch.sqrt(v + eps)
def _scatter_add(tgt, idx, src, axis=0):
    return tgt.clone().index_add_(axis, idx, src)
def _segment_sum(src, seg, n):
    out = torch.zeros((n,) + src.shape[1:], dtype=src.dtype)
    return out.index_add_(0, seg, src)
def _pad(x, pw):
    flat = tuple(v for pair in reversed(pw) for v in pair)
    return torch.nn.functional.pad(x, flat)

kernel_name = 'standalone__mha_block_cached__sampling'

def setup_inputs():

    _w = (lambda a: (lambda t: t.to(torch.bfloat16) if t.is_floating_point() else t)(torch.as_tensor(a)))
    B, Sq, D = 16, 1, 1024
    H, Sk, Dh = 32, 2048, 128
    return {
        "x": _w((lambda *s: torch.randn(*s, dtype=torch.bfloat16) * 0.8)(B, Sq, D)),
        "k_cache": _w((lambda *s: torch.randn(*s, dtype=torch.bfloat16) * 0.8)(B, H, Sk, Dh)),
        "v_cache": _w((lambda *s: torch.randn(*s, dtype=torch.bfloat16) * 0.05)(B, H, Sk, Dh)),
        "wq": _w((lambda *s: torch.randn(*s, dtype=torch.bfloat16) * 0.8)(D, H * Dh) * (D ** -0.5)),
        "wo": _w((lambda *s: torch.randn(*s, dtype=torch.bfloat16) * 0.05)(H * Dh, D) * ((H * Dh) ** -0.5)),
    }

def reference(x, k_cache, v_cache, wq, wo):
    B, Sq, D = x.shape
    H, Dh = 32, 128
    q = (lambda x, *d: x.permute(*d))((x @ wq).reshape(B, Sq, H, Dh), 0, 2, 1, 3)
    scores = torch.einsum("bhqd,bhkd->bhqk", q, k_cache) * (Dh ** -0.5)
    p = _softmax(scores, axis=-1)
    o = torch.einsum("bhqk,bhkd->bhqd", p, v_cache)
    return (lambda x, *d: x.permute(*d))(o, 0, 2, 1, 3).reshape(B, Sq, H * Dh) @ wo
```

```asm
; @launch grid=(256,1,1) block=(256,1,1) lds=81920
.amdgcn_target "amdgcn-amd-amdhsa--gfx950"
.text
.globl standalone__mha_block_cached__sampling_kernel
.p2align 8
.type standalone__mha_block_cached__sampling_kernel,@function
standalone__mha_block_cached__sampling_kernel:
  s_cmp_ge_u32 s2, 256
  s_cbranch_scc1 L_end
  s_load_dwordx16 s[4:19], s[0:1], 0
  v_and_b32 v1, 63, v0
  v_lshrrev_b32 v4, 6, v0
  v_and_b32 v2, 15, v0
  v_bfe_u32 v3, v0, 4, 2
  v_readfirstlane_b32 s54, v4
  s_and_b32 s78, s2, 7
  s_lshl_b32 s52, s78, 2
  s_bfe_u32 s55, s2, 0x20003
  s_add_u32 s52, s52, s55
  s_lshr_b32 s53, s2, 5
  s_lshl_b32 s79, s55, 3
  s_add_u32 s79, s79, s53
  v_lshrrev_b32 v57, 2, v1
  v_and_b32 v56, 3, v1
  v_lshlrev_b32 v56, 4, v56
  v_lshl_add_u32 v89, v57, 13, v56
  v_lshl_add_u32 v0, v57, 11, v56
  v_lshlrev_b32 v92, 11, v2
  v_lshl_add_u32 v92, v3, 4, v92
  s_lshr_b32 s69, s53, 2
  s_lshl_b32 s69, s69, 2
  s_add_u32 s69, s69, s54
  s_lshl_b32 s65, s69, 20
  s_lshl_b32 s69, s69, 8
  s_lshl_b32 s55, s52, 8
  s_add_u32 s65, s65, s55
  s_and_b32 s55, s53, 3
  s_lshl_b32 s55, s55, 6
  s_add_u32 s65, s65, s55
  s_lshl_b32 s70, s54, 13
  s_add_u32 s70, s70, 0x4000
  s_mov_b32 s30, 0x800000
  s_mov_b32 s31, 0x20000
  s_mov_b32 s38, 0x8000
  s_mov_b32 s39, 0x20000
  v_lshlrev_b32 v82, 4, v1
  v_lshlrev_b32 v56, 4, v2
  v_lshl_add_u32 v5, v3, 10, v56
  v_lshlrev_b32 v4, 8, v2
  v_lshl_add_u32 v4, v3, 4, v4
  v_lshl_add_u32 v91, v3, 11, v56
  v_lshlrev_b32 v93, 3, v1
  v_mov_b32 v83, 0
  v_mov_b32 v84, 1
  s_mov_b32 m0, s70
  s_waitcnt lgkmcnt(0)
  s_mov_b32 s28, s10
  s_and_b32 s29, s11, 0xffff
  buffer_load_dwordx4 v89, s[28:31], s65 offen nt lds
  s_add_u32 s70, s70, 0x400
  s_add_u32 s65, s65, 0x20000
  s_mov_b32 m0, s70
  s_nop 0
  buffer_load_dwordx4 v89, s[28:31], s65 offen nt lds
  s_add_u32 s70, s70, 0x400
  s_add_u32 s65, s65, 0x20000
  s_mov_b32 m0, s70
  s_nop 0
  buffer_load_dwordx4 v89, s[28:31], s65 offen nt lds
  s_add_u32 s70, s70, 0x400
  s_add_u32 s65, s65, 0x20000
  s_mov_b32 m0, s70
  s_nop 0
  buffer_load_dwordx4 v89, s[28:31], s65 offen nt lds
  s_add_u32 s70, s70, 0x400
  s_add_u32 s65, s65, 0x20000
  s_mov_b32 m0, s70
  s_nop 0
  buffer_load_dwordx4 v89, s[28:31], s65 offen nt lds
  s_add_u32 s70, s70, 0x400
  s_add_u32 s65, s65, 0x20000
  s_mov_b32 m0, s70
  s_nop 0
  buffer_load_dwordx4 v89, s[28:31], s65 offen nt lds
  s_add_u32 s70, s70, 0x400
  s_add_u32 s65, s65, 0x20000
  s_mov_b32 m0, s70
  s_nop 0
  buffer_load_dwordx4 v89, s[28:31], s65 offen nt lds
  s_add_u32 s70, s70, 0x400
  s_add_u32 s65, s65, 0x20000
  s_mov_b32 m0, s70
  s_nop 0
  buffer_load_dwordx4 v89, s[28:31], s65 offen nt lds
  s_add_u32 s70, s70, 0x400
  s_add_u32 s65, s65, 0x20000
  s_mov_b32 m0, s70
  s_mov_b32 s36, s4
  s_and_b32 s37, s5, 0xffff
  buffer_load_dwordx4 v[16:19], v92, s[36:39], s69 offen offset:0
  buffer_load_dwordx4 v[20:23], v92, s[36:39], s69 offen offset:64
  buffer_load_dwordx4 v[24:27], v92, s[36:39], s69 offen offset:128
  buffer_load_dwordx4 v[28:31], v92, s[36:39], s69 offen offset:192
  v_mov_b32 v79, 0x240
  ds_write_b32 v79, v83
  ds_write_b32 v79, v83 offset:4
  v_mov_b32 v64, -1
  v_mov_b32 v65, -1
  v_mov_b32 v66, -1
  v_mov_b32 v67, -1
  s_lshl_b32 s71, s78, 2
  s_add_u32 s71, s71, s54
  s_lshl_b32 s61, s71, 12
  s_add_u32 s61, s61, 0x80000
  s_lshl_b32 s71, s71, 18
  s_lshl_b32 s55, s79, 6
  s_add_u32 s71, s71, s55
  s_lshl_b32 s57, s52, 14
  s_lshl_b32 s55, s53, 11
  s_add_u32 s56, s57, s55
  s_lshr_b32 s55, s53, 1
  s_lshl_b32 s55, s55, 8
  s_add_u32 s57, s57, s55
  s_and_b32 s55, s53, 1
  s_lshl_b32 s55, s55, 3
  s_add_u32 s57, s57, s55
  s_add_u32 s75, s57, 0x1000
  s_add_u32 s76, s57, 0x2000
  s_add_u32 s77, s57, 0x3000
  s_lshl_b32 s67, s52, 12
  s_lshl_b32 s55, s53, 9
  s_add_u32 s67, s67, s55
  s_add_u32 s67, s67, 0x80000
  s_lshl_b32 s66, s79, 14
  s_lshl_b32 s55, s78, 8
  s_add_u32 s66, s66, s55
  s_add_u32 s66, s66, 0xa0000
  s_add_u32 s74, s66, 0x2000
  s_lshl_b32 s60, s53, 6
  s_add_u32 s60, s60, s52
  s_lshl_b32 s60, s60, 19
  s_lshl_b32 s55, s54, 12
  s_add_u32 s60, s60, s55
  s_and_b32 s64, s52, 1
  s_lshl_b32 s55, s64, 24
  s_xor_b32 s60, s60, s55
  s_mov_b32 s58, s60
  s_lshl_b32 s72, s52, 3
  s_add_u32 s3, s72, s53
  s_mov_b32 s40, s18
  s_and_b32 s41, s19, 0xffff
  s_mov_b32 s42, 0x120000
  s_mov_b32 s43, 0x20000
  s_mov_b32 s32, s12
  s_and_b32 s33, s13, 0xffff
  s_mov_b32 s34, 0x800000
  s_mov_b32 s35, 0x20000
  s_mov_b32 s20, s6
  s_and_b32 s21, s7, 0xffff
  s_mov_b32 s22, 0x10000000
  s_mov_b32 s23, 0x20000
  s_mov_b32 s24, s8
  s_and_b32 s25, s9, 0xffff
  s_mov_b32 s26, 0x10000000
  s_mov_b32 s27, 0x20000
  s_add_u32 s80, s70, 0x6000
  s_mov_b32 s81, s71
  s_cmp_lg_u32 s54, 0
  s_cbranch_scc1 L_nosnap
  buffer_load_dwordx4 v[32:35], v82, s[40:43], s56 offen sc1
  buffer_load_dwordx4 v[36:39], v82, s[40:43], s56 offen offset:1024 sc1
  buffer_load_dwordx2 v[40:41], v5, s[40:43], s57 offen sc1
  buffer_load_dwordx2 v[42:43], v5, s[40:43], s75 offen sc1
  buffer_load_dwordx2 v[44:45], v5, s[40:43], s76 offen sc1
  buffer_load_dwordx2 v[46:47], v5, s[40:43], s77 offen sc1
  buffer_store_dwordx4 v[64:67], v91, s[40:43], s66 offen sc1
  buffer_store_dwordx4 v[64:67], v91, s[40:43], s74 offen sc1
  buffer_store_dwordx2 v[64:65], v93, s[40:43], s67 offen sc1
  s_nop 0
L_nosnap:
  s_waitcnt lgkmcnt(0)
  s_barrier
  v_and_b32 v56, 7, v2
  v_lshlrev_b32 v80, 8, v56
  v_lshrrev_b32 v56, 3, v2
  v_lshl_add_u32 v80, v56, 6, v80
  v_lshl_add_u32 v80, v3, 4, v80
  s_mov_b32 m0, s80
  s_add_u32 s80, s80, 0x400
  buffer_load_dwordx4 v0, s[32:35], s81 offen nt lds
  s_add_u32 s81, s81, 0x8000
  s_mov_b32 m0, s80
  s_add_u32 s80, s80, 0x400
  buffer_load_dwordx4 v0, s[32:35], s81 offen nt lds
  s_add_u32 s81, s81, 0x8000
  s_mov_b32 m0, s80
  s_add_u32 s80, s80, 0x400
  buffer_load_dwordx4 v0, s[32:35], s81 offen nt lds
  s_add_u32 s81, s81, 0x8000
  s_mov_b32 m0, s80
  s_add_u32 s80, s80, 0x400
  buffer_load_dwordx4 v0, s[32:35], s81 offen nt lds
  s_add_u32 s81, s81, 0x8000
  s_mov_b32 m0, s80
  s_add_u32 s80, s80, 0x400
  buffer_load_dwordx4 v0, s[32:35], s81 offen nt lds
  s_add_u32 s81, s81, 0x8000
  s_mov_b32 m0, s80
  s_add_u32 s80, s80, 0x400
  buffer_load_dwordx4 v0, s[32:35], s81 offen nt lds
  s_add_u32 s81, s81, 0x8000
  s_mov_b32 m0, s80
  s_add_u32 s80, s80, 0x400
  buffer_load_dwordx4 v0, s[32:35], s81 offen nt lds
  s_add_u32 s81, s81, 0x8000
  s_mov_b32 m0, s80
  s_add_u32 s80, s80, 0x400
  buffer_load_dwordx4 v0, s[32:35], s81 offen nt lds
  s_add_u32 s81, s81, 0x8000
  buffer_load_dwordx4 v[128:131], v80, s[20:23], s58 offen offset:0 nt
  buffer_load_dwordx4 v[132:135], v80, s[20:23], s58 offen offset:128 nt
  buffer_load_dwordx4 v[136:139], v80, s[20:23], s58 offen offset:2048 nt
  buffer_load_dwordx4 v[140:143], v80, s[20:23], s58 offen offset:2176 nt
  buffer_load_dwordx4 v[144:147], v5, s[24:27], s58 offen offset:0 nt
  buffer_load_dwordx4 v[148:151], v5, s[24:27], s58 offen offset:256 nt
  buffer_load_dwordx4 v[152:155], v5, s[24:27], s58 offen offset:512 nt
  buffer_load_dwordx4 v[156:159], v5, s[24:27], s58 offen offset:768 nt
  s_add_u32 s58, s58, 0x4000
  buffer_load_dwordx4 v[160:163], v80, s[20:23], s58 offen offset:0 nt
  buffer_load_dwordx4 v[164:167], v80, s[20:23], s58 offen offset:128 nt
  buffer_load_dwordx4 v[168:171], v80, s[20:23], s58 offen offset:2048 nt
  buffer_load_dwordx4 v[172:175], v80, s[20:23], s58 offen offset:2176 nt
  buffer_load_dwordx4 v[176:179], v5, s[24:27], s58 offen offset:0 nt
  buffer_load_dwordx4 v[180:183], v5, s[24:27], s58 offen offset:256 nt
  buffer_load_dwordx4 v[184:187], v5, s[24:27], s58 offen offset:512 nt
  buffer_load_dwordx4 v[188:191], v5, s[24:27], s58 offen offset:768 nt
  s_add_u32 s58, s58, 0x4000
  s_mov_b32 s44, s14
  s_and_b32 s45, s15, 0xffff
  s_mov_b32 s46, 0x8000
  s_mov_b32 s47, 0x20000
  s_mov_b32 s48, s16
  s_and_b32 s49, s17, 0xffff
  s_mov_b32 s50, 0x100
  s_mov_b32 s51, 0x20000
  v_and_b32 v56, 1, v1
  v_cmp_eq_u32 vcc, 1, v56
  v_mov_b32 v57, 0x0c0c0100
  v_mov_b32 v58, 0x01000c0c
  v_mov_b32 v59, 0x0c0c0302
  v_mov_b32 v60, 0x03020c0c
  v_cndmask_b32 v57, v57, v58, vcc
  v_cndmask_b32 v59, v59, v60, vcc
  v_mov_b32 v58, 0x0c0c0c0c
  v_bfe_u32 v56, v1, 1, 2
  v_cmp_eq_u32 vcc, 0, v56
  s_nop 1
  v_cndmask_b32 v8, v58, v57, vcc
  v_cndmask_b32 v12, v58, v59, vcc
  v_cmp_eq_u32 vcc, 1, v56
  s_nop 1
  v_cndmask_b32 v9, v58, v57, vcc
  v_cndmask_b32 v13, v58, v59, vcc
  v_cmp_eq_u32 vcc, 2, v56
  s_nop 1
  v_cndmask_b32 v10, v58, v57, vcc
  v_cndmask_b32 v14, v58, v59, vcc
  v_cmp_eq_u32 vcc, 3, v56
  s_nop 1
  v_cndmask_b32 v11, v58, v57, vcc
  v_cndmask_b32 v15, v58, v59, vcc
  s_lshl_b32 s55, s54, 13
  v_lshrrev_b32 v56, 2, v2
  v_lshl_add_u32 v56, v3, 3, v56
  v_lshlrev_b32 v56, 6, v56
  v_and_b32 v57, 3, v2
  v_lshl_add_u32 v95, v57, 3, v56
  s_add_u32 s55, s55, 0xc000
  v_add_u32 v95, s55, v95
  v_subrev_u32 v94, 0x8000, v95
  s_mov_b32 s59, 0x3e0293ee
  v_lshlrev_b32 v85, 2, v1
  v_lshlrev_b32 v86, 1, v1
  s_lshl_b32 s55, s64, 8
  v_lshlrev_b32 v87, 4, v3
  v_add_u32 v87, s55, v87
  v_xor_b32 v88, 0x100, v87
  s_lshl_b32 s55, s54, 9
  s_lshl_b32 s65, s64, 11
  s_add_u32 s55, s55, s65
  v_and_b32 v6, 7, v1
  v_lshlrev_b32 v6, 2, v6
  v_lshl_add_u32 v6, v3, 7, v6
  v_add_u32 v6, s55, v6
  s_lshl_b32 s55, s54, 3
  s_lshl_b32 s65, s64, 5
  s_add_u32 s55, s55, s65
  v_mov_b32 v7, s55
  s_lshl_b32 s55, s54, 11
  v_add_u32 v90, s55, v82
  s_cmp_lg_u32 s54, 0
  s_cbranch_scc1 L_w16
  s_waitcnt vmcnt(33)
  s_branch L_wdone
L_w16:
  s_waitcnt vmcnt(24)
L_wdone:
  ds_read_b64_tr_b16 v[96:97], v94 offset:0
  ds_read_b64_tr_b16 v[98:99], v94 offset:256
  ds_read_b64_tr_b16 v[100:101], v94 offset:32
  ds_read_b64_tr_b16 v[102:103], v94 offset:288
  ds_read_b64_tr_b16 v[104:105], v94 offset:2048
  ds_read_b64_tr_b16 v[106:107], v94 offset:2304
  ds_read_b64_tr_b16 v[108:109], v94 offset:2080
  ds_read_b64_tr_b16 v[110:111], v94 offset:2336
  ds_read_b64_tr_b16 v[112:113], v94 offset:4096
  ds_read_b64_tr_b16 v[114:115], v94 offset:4352
  ds_read_b64_tr_b16 v[116:117], v94 offset:4128
  ds_read_b64_tr_b16 v[118:119], v94 offset:4384
  s_waitcnt lgkmcnt(8)
  ds_read_b64_tr_b16 v[120:121], v94 offset:6144
  ds_read_b64_tr_b16 v[122:123], v94 offset:6400
  ds_read_b64_tr_b16 v[124:125], v94 offset:6176
  ds_read_b64_tr_b16 v[126:127], v94 offset:6432
  s_waitcnt lgkmcnt(0)
  v_mfma_f32_16x16x32_bf16 v[48:51], v[16:19], v[96:99], 0
  v_mfma_f32_16x16x32_bf16 v[52:55], v[16:19], v[100:103], 0
  v_mfma_f32_16x16x32_bf16 v[48:51], v[20:23], v[104:107], v[48:51]
  v_mfma_f32_16x16x32_bf16 v[52:55], v[20:23], v[108:111], v[52:55]
  v_mfma_f32_16x16x32_bf16 v[48:51], v[24:27], v[112:115], v[48:51]
  v_mfma_f32_16x16x32_bf16 v[52:55], v[24:27], v[116:119], v[52:55]
  v_mfma_f32_16x16x32_bf16 v[48:51], v[28:31], v[120:123], v[48:51]
  v_mfma_f32_16x16x32_bf16 v[52:55], v[28:31], v[124:127], v[52:55]
  s_nop 6
  ds_write_b128 v90, v[48:51] offset:5120
  ds_write_b128 v90, v[52:55] offset:6144
  s_cmp_lg_u32 s54, 0
  s_cbranch_scc1 L_waitq
  s_mov_b32 s69, 25600000
L_rspin:
  ds_read_b32 v78, v79 offset:4
  s_waitcnt lgkmcnt(0)
  v_readfirstlane_b32 s55, v78
  s_nop 0
  s_cmp_eq_u32 s55, 192
  s_nop 1
  s_cbranch_scc1 L_rok
  s_sub_u32 s69, s69, 1
  s_cbranch_scc0 L_rspin
L_rok:
  ds_read_b128 v[96:99], v82 offset:7168
  ds_read_b128 v[100:103], v82 offset:8192
  ds_read_b128 v[104:107], v82 offset:9216
  ds_read_b128 v[108:111], v82 offset:10240
  ds_read_b128 v[112:115], v82 offset:11264
  ds_read_b128 v[116:119], v82 offset:12288
  s_waitcnt vmcnt(27)
  v_not_b32 v32, v32
  v_not_b32 v33, v33
  v_not_b32 v34, v34
  v_not_b32 v35, v35
  v_not_b32 v36, v36
  v_not_b32 v37, v37
  v_not_b32 v38, v38
  v_not_b32 v39, v39
  s_waitcnt lgkmcnt(0)
  v_add_f32 v48, v48, v96
  v_add_f32 v104, v104, v112
  v_add_f32 v49, v49, v97
  v_add_f32 v105, v105, v113
  v_add_f32 v50, v50, v98
  v_add_f32 v106, v106, v114
  v_add_f32 v51, v51, v99
  v_add_f32 v107, v107, v115
  v_add_f32 v52, v52, v100
  v_add_f32 v108, v108, v116
  v_add_f32 v53, v53, v101
  v_add_f32 v109, v109, v117
  v_add_f32 v54, v54, v102
  v_add_f32 v110, v110, v118
  v_add_f32 v55, v55, v103
  v_add_f32 v111, v111, v119
  v_add_f32 v48, v48, v104
  v_add_f32 v49, v49, v105
  v_add_f32 v50, v50, v106
  v_add_f32 v51, v51, v107
  v_add_f32 v52, v52, v108
  v_add_f32 v53, v53, v109
  v_add_f32 v54, v54, v110
  v_add_f32 v55, v55, v111
  v_bfi_b32 v48, 1, v32, v48
  v_bfi_b32 v49, 1, v33, v49
  v_bfi_b32 v50, 1, v34, v50
  v_bfi_b32 v51, 1, v35, v51
  v_bfi_b32 v52, 1, v36, v52
  v_bfi_b32 v53, 1, v37, v53
  v_bfi_b32 v54, 1, v38, v54
  v_bfi_b32 v55, 1, v39, v55
  buffer_store_dwordx4 v[48:51], v82, s[40:43], s56 offen sc1
  buffer_store_dwordx4 v[52:55], v82, s[40:43], s56 offen offset:1024 sc1
  s_mov_b32 s69, 0
  s_nop 0
  buffer_load_dwordx4 v[192:195], v80, s[20:23], s58 offen offset:0 nt
  buffer_load_dwordx4 v[196:199], v80, s[20:23], s58 offen offset:128 nt
  buffer_load_dwordx4 v[200:203], v80, s[20:23], s58 offen offset:2048 nt
  buffer_load_dwordx4 v[204:207], v80, s[20:23], s58 offen offset:2176 nt
  buffer_load_dwordx4 v[208:211], v5, s[24:27], s58 offen offset:0 nt
  buffer_load_dwordx4 v[212:215], v5, s[24:27], s58 offen offset:256 nt
  buffer_load_dwordx4 v[216:219], v5, s[24:27], s58 offen offset:512 nt
  buffer_load_dwordx4 v[220:223], v5, s[24:27], s58 offen offset:768 nt
  s_add_u32 s58, s58, 0x4000
  s_waitcnt vmcnt(8)
  s_mov_b64 exec, 1
  buffer_store_byte v84, v83, s[48:51], s3 offen sc1
  s_mov_b64 exec, -1
  buffer_load_dwordx2 v[96:97], v5, s[40:43], s57 offen sc1
  buffer_load_dwordx2 v[98:99], v5, s[40:43], s75 offen sc1
  buffer_load_dwordx2 v[100:101], v5, s[40:43], s76 offen sc1
  buffer_load_dwordx2 v[102:103], v5, s[40:43], s77 offen sc1
  buffer_load_dwordx4 v[224:227], v80, s[20:23], s58 offen offset:0 nt
  buffer_load_dwordx4 v[228:231], v80, s[20:23], s58 offen offset:128 nt
  buffer_load_dwordx4 v[232:235], v80, s[20:23], s58 offen offset:2048 nt
  buffer_load_dwordx4 v[236:239], v80, s[20:23], s58 offen offset:2176 nt
  buffer_load_dwordx4 v[240:243], v5, s[24:27], s58 offen offset:0 nt
  buffer_load_dwordx4 v[244:247], v5, s[24:27], s58 offen offset:256 nt
  buffer_load_dwordx4 v[248:251], v5, s[24:27], s58 offen offset:512 nt
  buffer_load_dwordx4 v[252:255], v5, s[24:27], s58 offen offset:768 nt
  s_add_u32 s58, s58, 0x4000
  s_waitcnt vmcnt(8)
  s_mov_b32 s68, 4
  s_call_b64 s[62:63], L_qchk
  buffer_load_dwordx2 v[96:97], v5, s[40:43], s57 offen sc1
  buffer_load_dwordx2 v[98:99], v5, s[40:43], s75 offen sc1
  buffer_load_dwordx2 v[100:101], v5, s[40:43], s76 offen sc1
  buffer_load_dwordx2 v[102:103], v5, s[40:43], s77 offen sc1
  buffer_load_dwordx4 a[0:3], v80, s[20:23], s58 offen offset:0 nt
  buffer_load_dwordx4 a[4:7], v80, s[20:23], s58 offen offset:128 nt
  buffer_load_dwordx4 a[8:11], v80, s[20:23], s58 offen offset:2048 nt
  buffer_load_dwordx4 a[12:15], v80, s[20:23], s58 offen offset:2176 nt
  buffer_load_dwordx4 a[16:19], v5, s[24:27], s58 offen offset:0 nt
  buffer_load_dwordx4 a[20:23], v5, s[24:27], s58 offen offset:256 nt
  buffer_load_dwordx4 a[24:27], v5, s[24:27], s58 offen offset:512 nt
  buffer_load_dwordx4 a[28:31], v5, s[24:27], s58 offen offset:768 nt
  s_add_u32 s58, s58, 0x4000
  s_waitcnt vmcnt(8)
  s_mov_b32 s68, 5
  s_call_b64 s[62:63], L_qchk
  buffer_load_dwordx2 v[96:97], v5, s[40:43], s57 offen sc1
  buffer_load_dwordx2 v[98:99], v5, s[40:43], s75 offen sc1
  buffer_load_dwordx2 v[100:101], v5, s[40:43], s76 offen sc1
  buffer_load_dwordx2 v[102:103], v5, s[40:43], s77 offen sc1
  buffer_load_dwordx4 a[32:35], v80, s[20:23], s58 offen offset:0 nt
  buffer_load_dwordx4 a[36:39], v80, s[20:23], s58 offen offset:128 nt
  buffer_load_dwordx4 a[40:43], v80, s[20:23], s58 offen offset:2048 nt
  buffer_load_dwordx4 a[44:47], v80, s[20:23], s58 offen offset:2176 nt
  buffer_load_dwordx4 a[48:51], v5, s[24:27], s58 offen offset:0 nt
  buffer_load_dwordx4 a[52:55], v5, s[24:27], s58 offen offset:256 nt
  buffer_load_dwordx4 a[56:59], v5, s[24:27], s58 offen offset:512 nt
  buffer_load_dwordx4 a[60:63], v5, s[24:27], s58 offen offset:768 nt
  s_add_u32 s58, s58, 0x4000
  s_waitcnt vmcnt(8)
  s_mov_b32 s68, 6
  s_call_b64 s[62:63], L_qchk
  buffer_load_dwordx2 v[96:97], v5, s[40:43], s57 offen sc1
  buffer_load_dwordx2 v[98:99], v5, s[40:43], s75 offen sc1
  buffer_load_dwordx2 v[100:101], v5, s[40:43], s76 offen sc1
  buffer_load_dwordx2 v[102:103], v5, s[40:43], s77 offen sc1
  buffer_load_dwordx4 a[64:67], v80, s[20:23], s58 offen offset:0 nt
  buffer_load_dwordx4 a[68:71], v80, s[20:23], s58 offen offset:128 nt
  buffer_load_dwordx4 a[72:75], v80, s[20:23], s58 offen offset:2048 nt
  buffer_load_dwordx4 a[76:79], v80, s[20:23], s58 offen offset:2176 nt
  buffer_load_dwordx4 a[80:83], v5, s[24:27], s58 offen offset:0 nt
  buffer_load_dwordx4 a[84:87], v5, s[24:27], s58 offen offset:256 nt
  buffer_load_dwordx4 a[88:91], v5, s[24:27], s58 offen offset:512 nt
  buffer_load_dwordx4 a[92:95], v5, s[24:27], s58 offen offset:768 nt
  s_add_u32 s58, s58, 0x4000
  s_waitcnt vmcnt(8)
  s_mov_b32 s68, 7
  s_call_b64 s[62:63], L_qchk
  buffer_load_dwordx2 v[96:97], v5, s[40:43], s57 offen sc1
  buffer_load_dwordx2 v[98:99], v5, s[40:43], s75 offen sc1
  buffer_load_dwordx2 v[100:101], v5, s[40:43], s76 offen sc1
  buffer_load_dwordx2 v[102:103], v5, s[40:43], s77 offen sc1
  buffer_load_dwordx4 a[96:99], v80, s[20:23], s58 offen offset:0 nt
  buffer_load_dwordx4 a[100:103], v80, s[20:23], s58 offen offset:128 nt
  buffer_load_dwordx4 a[104:107], v80, s[20:23], s58 offen offset:2048 nt
  buffer_load_dwordx4 a[108:111], v80, s[20:23], s58 offen offset:2176 nt
  buffer_load_dwordx4 a[112:115], v5, s[24:27], s58 offen offset:0 nt
  buffer_load_dwordx4 a[116:119], v5, s[24:27], s58 offen offset:256 nt
  buffer_load_dwordx4 a[120:123], v5, s[24:27], s58 offen offset:512 nt
  buffer_load_dwordx4 a[124:127], v5, s[24:27], s58 offen offset:768 nt
  s_add_u32 s58, s58, 0x4000
  s_mov_b32 s68, 8
  s_waitcnt vmcnt(8)
L_qpoll:
  s_call_b64 s[62:63], L_qchk
  s_add_u32 s69, s69, 1
  s_cmp_lt_u32 s69, 3
  s_cbranch_scc1 L_qagain
  buffer_load_dwordx2 v[56:57], v83, s[48:51], s72 offen sc1
  s_waitcnt vmcnt(0)
  v_and_b32 v56, v56, v57
  s_nop 0
  v_readfirstlane_b32 s55, v56
  s_nop 0
  s_cmp_eq_u32 s55, 0x01010101
  s_nop 1
  s_cbranch_scc1 L_qtrust
  s_cmp_gt_u32 s69, 100000
  s_cbranch_scc1 L_qtrust
L_qagain:
  buffer_load_dwordx2 v[96:97], v5, s[40:43], s57 offen sc1
  buffer_load_dwordx2 v[98:99], v5, s[40:43], s75 offen sc1
  buffer_load_dwordx2 v[100:101], v5, s[40:43], s76 offen sc1
  buffer_load_dwordx2 v[102:103], v5, s[40:43], s77 offen sc1
  s_waitcnt vmcnt(0)
  s_branch L_qpoll
L_qchk:
  v_xor_b32 v56, v96, v40
  v_xor_b32 v57, v97, v41
  v_xor_b32 v58, v98, v42
  v_xor_b32 v59, v99, v43
  v_xor_b32 v60, v100, v44
  v_xor_b32 v61, v101, v45
  v_xor_b32 v62, v102, v46
  v_xor_b32 v63, v103, v47
  v_and_b32 v56, v56, v57
  v_and_b32 v58, v58, v59
  v_and_b32 v60, v60, v61
  v_and_b32 v62, v62, v63
  v_and_b32 v56, v56, v58
  v_and_b32 v60, v60, v62
  v_and_b32 v56, v56, v60
  v_and_b32 v56, 1, v56
  v_cmp_eq_u32 vcc, 0, v56
  s_nop 3
  s_cbranch_vccz L_qok
  s_setpc_b64 s[62:63]
L_qtrust:
  buffer_load_dwordx2 v[96:97], v5, s[40:43], s57 offen sc1
  buffer_load_dwordx2 v[98:99], v5, s[40:43], s75 offen sc1
  buffer_load_dwordx2 v[100:101], v5, s[40:43], s76 offen sc1
  buffer_load_dwordx2 v[102:103], v5, s[40:43], s77 offen sc1
  s_waitcnt vmcnt(0)
L_qok:
  v_and_b32 v96, -2, v96
  v_and_b32 v97, -2, v97
  v_and_b32 v98, -2, v98
  v_and_b32 v99, -2, v99
  v_and_b32 v100, -2, v100
  v_and_b32 v101, -2, v101
  v_and_b32 v102, -2, v102
  v_and_b32 v103, -2, v103
  v_add_f32 v48, v96, v100
  v_add_f32 v49, v97, v101
  v_add_f32 v50, v98, v102
  v_add_f32 v51, v99, v103
  v_cvt_pk_bf16_f32 v62, v48, v49
  v_cvt_pk_bf16_f32 v63, v50, v51
  ds_write_b16 v86, v62 offset:0
  ds_write_b16_d16_hi v86, v62 offset:256
  ds_write_b16 v86, v63 offset:128
  ds_write_b16_d16_hi v86, v63 offset:384
  ds_write_b32 v79, v84
  s_cmp_eq_u32 s68, 4
  s_cbranch_scc1 L_fastK4
  s_cmp_eq_u32 s68, 5
  s_cbranch_scc1 L_fastK5
  s_cmp_eq_u32 s68, 6
  s_cbranch_scc1 L_fastK6
  s_cmp_eq_u32 s68, 7
  s_cbranch_scc1 L_fastK7
  s_branch L_qdone
L_waitq:
  ds_add_u32 v79, v84 offset:4
  ds_read_b32 v78, v79
  s_waitcnt vmcnt(12) lgkmcnt(0)
  v_readfirstlane_b32 s55, v78
  ds_read_b32 v78, v79
  s_cmp_lg_u32 s55, 0
  s_nop 1
  s_cbranch_scc1 L_fastK2
  buffer_load_dwordx4 v[192:195], v80, s[20:23], s58 offen offset:0 nt
  buffer_load_dwordx4 v[196:199], v80, s[20:23], s58 offen offset:128 nt
  buffer_load_dwordx4 v[200:203], v80, s[20:23], s58 offen offset:2048 nt
  buffer_load_dwordx4 v[204:207], v80, s[20:23], s58 offen offset:2176 nt
  s_waitcnt vmcnt(12) lgkmcnt(0)
  v_readfirstlane_b32 s55, v78
  ds_read_b32 v78, v79
  s_cmp_lg_u32 s55, 0
  s_nop 1
  s_cbranch_scc1 L_fastV2
  buffer_load_dwordx4 v[208:211], v5, s[24:27], s58 offen offset:0 nt
  buffer_load_dwordx4 v[212:215], v5, s[24:27], s58 offen offset:256 nt
  buffer_load_dwordx4 v[216:219], v5, s[24:27], s58 offen offset:512 nt
  buffer_load_dwordx4 v[220:223], v5, s[24:27], s58 offen offset:768 nt
  s_add_u32 s58, s58, 0x4000
  s_waitcnt vmcnt(12) lgkmcnt(0)
  v_readfirstlane_b32 s55, v78
  ds_read_b32 v78, v79
  s_cmp_lg_u32 s55, 0
  s_nop 1
  s_cbranch_scc1 L_fastK3
  buffer_load_dwordx4 v[224:227], v80, s[20:23], s58 offen offset:0 nt
  buffer_load_dwordx4 v[228:231], v80, s[20:23], s58 offen offset:128 nt
  buffer_load_dwordx4 v[232:235], v80, s[20:23], s58 offen offset:2048 nt
  buffer_load_dwordx4 v[236:239], v80, s[20:23], s58 offen offset:2176 nt
  s_waitcnt vmcnt(12) lgkmcnt(0)
  v_readfirstlane_b32 s55, v78
  ds_read_b32 v78, v79
  s_cmp_lg_u32 s55, 0
  s_nop 1
  s_cbranch_scc1 L_fastV3
  buffer_load_dwordx4 v[240:243], v5, s[24:27], s58 offen offset:0 nt
  buffer_load_dwordx4 v[244:247], v5, s[24:27], s58 offen offset:256 nt
  buffer_load_dwordx4 v[248:251], v5, s[24:27], s58 offen offset:512 nt
  buffer_load_dwordx4 v[252:255], v5, s[24:27], s58 offen offset:768 nt
  s_add_u32 s58, s58, 0x4000
  s_waitcnt vmcnt(12) lgkmcnt(0)
  v_readfirstlane_b32 s55, v78
  ds_read_b32 v78, v79
  s_cmp_lg_u32 s55, 0
  s_nop 1
  s_cbranch_scc1 L_fastK4
  buffer_load_dwordx4 a[0:3], v80, s[20:23], s58 offen offset:0 nt
  buffer_load_dwordx4 a[4:7], v80, s[20:23], s58 offen offset:128 nt
  buffer_load_dwordx4 a[8:11], v80, s[20:23], s58 offen offset:2048 nt
  buffer_load_dwordx4 a[12:15], v80, s[20:23], s58 offen offset:2176 nt
  s_waitcnt vmcnt(12) lgkmcnt(0)
  v_readfirstlane_b32 s55, v78
  ds_read_b32 v78, v79
  s_cmp_lg_u32 s55, 0
  s_nop 1
  s_cbranch_scc1 L_fastV4
  buffer_load_dwordx4 a[16:19], v5, s[24:27], s58 offen offset:0 nt
  buffer_load_dwordx4 a[20:23], v5, s[24:27], s58 offen offset:256 nt
  buffer_load_dwordx4 a[24:27], v5, s[24:27], s58 offen offset:512 nt
  buffer_load_dwordx4 a[28:31], v5, s[24:27], s58 offen offset:768 nt
  s_add_u32 s58, s58, 0x4000
  s_waitcnt vmcnt(12) lgkmcnt(0)
  v_readfirstlane_b32 s55, v78
  ds_read_b32 v78, v79
  s_cmp_lg_u32 s55, 0
  s_nop 1
  s_cbranch_scc1 L_fastK5
  buffer_load_dwordx4 a[32:35], v80, s[20:23], s58 offen offset:0 nt
  buffer_load_dwordx4 a[36:39], v80, s[20:23], s58 offen offset:128 nt
  buffer_load_dwordx4 a[40:43], v80, s[20:23], s58 offen offset:2048 nt
  buffer_load_dwordx4 a[44:47], v80, s[20:23], s58 offen offset:2176 nt
  s_waitcnt vmcnt(12) lgkmcnt(0)
  v_readfirstlane_b32 s55, v78
  ds_read_b32 v78, v79
  s_cmp_lg_u32 s55, 0
  s_nop 1
  s_cbranch_scc1 L_fastV5
  buffer_load_dwordx4 a[48:51], v5, s[24:27], s58 offen offset:0 nt
  buffer_load_dwordx4 a[52:55], v5, s[24:27], s58 offen offset:256 nt
  buffer_load_dwordx4 a[56:59], v5, s[24:27], s58 offen offset:512 nt
  buffer_load_dwordx4 a[60:63], v5, s[24:27], s58 offen offset:768 nt
  s_add_u32 s58, s58, 0x4000
  s_waitcnt vmcnt(12) lgkmcnt(0)
  v_readfirstlane_b32 s55, v78
  ds_read_b32 v78, v79
  s_cmp_lg_u32 s55, 0
  s_nop 1
  s_cbranch_scc1 L_fastK6
  buffer_load_dwordx4 a[64:67], v80, s[20:23], s58 offen offset:0 nt
  buffer_load_dwordx4 a[68:71], v80, s[20:23], s58 offen offset:128 nt
  buffer_load_dwordx4 a[72:75], v80, s[20:23], s58 offen offset:2048 nt
  buffer_load_dwordx4 a[76:79], v80, s[20:23], s58 offen offset:2176 nt
  s_waitcnt vmcnt(12) lgkmcnt(0)
  v_readfirstlane_b32 s55, v78
  ds_read_b32 v78, v79
  s_cmp_lg_u32 s55, 0
  s_nop 1
  s_cbranch_scc1 L_fastV6
  buffer_load_dwordx4 a[80:83], v5, s[24:27], s58 offen offset:0 nt
  buffer_load_dwordx4 a[84:87], v5, s[24:27], s58 offen offset:256 nt
  buffer_load_dwordx4 a[88:91], v5, s[24:27], s58 offen offset:512 nt
  buffer_load_dwordx4 a[92:95], v5, s[24:27], s58 offen offset:768 nt
  s_add_u32 s58, s58, 0x4000
  s_waitcnt vmcnt(12) lgkmcnt(0)
  v_readfirstlane_b32 s55, v78
  ds_read_b32 v78, v79
  s_cmp_lg_u32 s55, 0
  s_nop 1
  s_cbranch_scc1 L_fastK7
  buffer_load_dwordx4 a[96:99], v80, s[20:23], s58 offen offset:0 nt
  buffer_load_dwordx4 a[100:103], v80, s[20:23], s58 offen offset:128 nt
  buffer_load_dwordx4 a[104:107], v80, s[20:23], s58 offen offset:2048 nt
  buffer_load_dwordx4 a[108:111], v80, s[20:23], s58 offen offset:2176 nt
  s_waitcnt vmcnt(12) lgkmcnt(0)
  v_readfirstlane_b32 s55, v78
  ds_read_b32 v78, v79
  s_cmp_lg_u32 s55, 0
  s_nop 1
  s_cbranch_scc1 L_fastV7
  buffer_load_dwordx4 a[112:115], v5, s[24:27], s58 offen offset:0 nt
  buffer_load_dwordx4 a[116:119], v5, s[24:27], s58 offen offset:256 nt
  buffer_load_dwordx4 a[120:123], v5, s[24:27], s58 offen offset:512 nt
  buffer_load_dwordx4 a[124:127], v5, s[24:27], s58 offen offset:768 nt
  s_add_u32 s58, s58, 0x4000
  s_mov_b32 s70, 25600000
L_qspin:
  s_waitcnt lgkmcnt(0)
  v_readfirstlane_b32 s55, v78
  ds_read_b32 v78, v79
  s_cmp_lg_u32 s55, 0
  s_nop 1
  s_cbranch_scc1 L_qdone
  s_sleep 1
  s_sub_u32 s70, s70, 1
  s_cbranch_scc0 L_qspin
  s_branch L_qdone
L_fastK2:
  s_waitcnt vmcnt(48)
  buffer_load_dwordx4 v[192:195], v80, s[20:23], s58 offen offset:0 nt
  buffer_load_dwordx4 v[196:199], v80, s[20:23], s58 offen offset:128 nt
  buffer_load_dwordx4 v[200:203], v80, s[20:23], s58 offen offset:2048 nt
  buffer_load_dwordx4 v[204:207], v80, s[20:23], s58 offen offset:2176 nt
L_fastV2:
  buffer_load_dwordx4 v[208:211], v5, s[24:27], s58 offen offset:0 nt
  buffer_load_dwordx4 v[212:215], v5, s[24:27], s58 offen offset:256 nt
  buffer_load_dwordx4 v[216:219], v5, s[24:27], s58 offen offset:512 nt
  buffer_load_dwordx4 v[220:223], v5, s[24:27], s58 offen offset:768 nt
  s_add_u32 s58, s58, 0x4000
L_fastK3:
  s_waitcnt vmcnt(48)
  buffer_load_dwordx4 v[224:227], v80, s[20:23], s58 offen offset:0 nt
  buffer_load_dwordx4 v[228:231], v80, s[20:23], s58 offen offset:128 nt
  buffer_load_dwordx4 v[232:235], v80, s[20:23], s58 offen offset:2048 nt
  buffer_load_dwordx4 v[236:239], v80, s[20:23], s58 offen offset:2176 nt
L_fastV3:
  buffer_load_dwordx4 v[240:243], v5, s[24:27], s58 offen offset:0 nt
  buffer_load_dwordx4 v[244:247], v5, s[24:27], s58 offen offset:256 nt
  buffer_load_dwordx4 v[248:251], v5, s[24:27], s58 offen offset:512 nt
  buffer_load_dwordx4 v[252:255], v5, s[24:27], s58 offen offset:768 nt
  s_add_u32 s58, s58, 0x4000
L_fastK4:
  s_waitcnt vmcnt(48)
  buffer_load_dwordx4 a[0:3], v80, s[20:23], s58 offen offset:0 nt
  buffer_load_dwordx4 a[4:7], v80, s[20:23], s58 offen offset:128 nt
  buffer_load_dwordx4 a[8:11], v80, s[20:23], s58 offen offset:2048 nt
  buffer_load_dwordx4 a[12:15], v80, s[20:23], s58 offen offset:2176 nt
L_fastV4:
  buffer_load_dwordx4 a[16:19], v5, s[24:27], s58 offen offset:0 nt
  buffer_load_dwordx4 a[20:23], v5, s[24:27], s58 offen offset:256 nt
  buffer_load_dwordx4 a[24:27], v5, s[24:27], s58 offen offset:512 nt
  buffer_load_dwordx4 a[28:31], v5, s[24:27], s58 offen offset:768 nt
  s_add_u32 s58, s58, 0x4000
L_fastK5:
  s_waitcnt vmcnt(48)
  buffer_load_dwordx4 a[32:35], v80, s[20:23], s58 offen offset:0 nt
  buffer_load_dwordx4 a[36:39], v80, s[20:23], s58 offen offset:128 nt
  buffer_load_dwordx4 a[40:43], v80, s[20:23], s58 offen offset:2048 nt
  buffer_load_dwordx4 a[44:47], v80, s[20:23], s58 offen offset:2176 nt
L_fastV5:
  buffer_load_dwordx4 a[48:51], v5, s[24:27], s58 offen offset:0 nt
  buffer_load_dwordx4 a[52:55], v5, s[24:27], s58 offen offset:256 nt
  buffer_load_dwordx4 a[56:59], v5, s[24:27], s58 offen offset:512 nt
  buffer_load_dwordx4 a[60:63], v5, s[24:27], s58 offen offset:768 nt
  s_add_u32 s58, s58, 0x4000
L_fastK6:
  s_waitcnt vmcnt(48)
  buffer_load_dwordx4 a[64:67], v80, s[20:23], s58 offen offset:0 nt
  buffer_load_dwordx4 a[68:71], v80, s[20:23], s58 offen offset:128 nt
  buffer_load_dwordx4 a[72:75], v80, s[20:23], s58 offen offset:2048 nt
  buffer_load_dwordx4 a[76:79], v80, s[20:23], s58 offen offset:2176 nt
L_fastV6:
  buffer_load_dwordx4 a[80:83], v5, s[24:27], s58 offen offset:0 nt
  buffer_load_dwordx4 a[84:87], v5, s[24:27], s58 offen offset:256 nt
  buffer_load_dwordx4 a[88:91], v5, s[24:27], s58 offen offset:512 nt
  buffer_load_dwordx4 a[92:95], v5, s[24:27], s58 offen offset:768 nt
  s_add_u32 s58, s58, 0x4000
L_fastK7:
  s_waitcnt vmcnt(48)
  buffer_load_dwordx4 a[96:99], v80, s[20:23], s58 offen offset:0 nt
  buffer_load_dwordx4 a[100:103], v80, s[20:23], s58 offen offset:128 nt
  buffer_load_dwordx4 a[104:107], v80, s[20:23], s58 offen offset:2048 nt
  buffer_load_dwordx4 a[108:111], v80, s[20:23], s58 offen offset:2176 nt
L_fastV7:
  buffer_load_dwordx4 a[112:115], v5, s[24:27], s58 offen offset:0 nt
  buffer_load_dwordx4 a[116:119], v5, s[24:27], s58 offen offset:256 nt
  buffer_load_dwordx4 a[120:123], v5, s[24:27], s58 offen offset:512 nt
  buffer_load_dwordx4 a[124:127], v5, s[24:27], s58 offen offset:768 nt
  s_add_u32 s58, s58, 0x4000
L_qdone:
  v_mov_b32 v89, v80
  ds_read_b128 v[16:19], v87 offset:0
  ds_read_b128 v[20:23], v87 offset:64
  ds_read_b128 v[24:27], v87 offset:128
  ds_read_b128 v[28:31], v87 offset:192
  v_and_b32 v56, 1, v2
  v_lshl_add_u32 v56, v56, 6, v87
  ds_read_b128 v[32:35], v56 offset:0
  ds_read_b128 v[36:39], v56 offset:128
  v_mov_b32 v80, 0xf149f2ca
  v_mov_b32 v81, 0
  v_mov_b32 v48, 0
  v_mov_b32 v49, 0
  v_mov_b32 v50, 0
  v_mov_b32 v51, 0
  s_add_u32 s65, s66, 0x2000
  s_waitcnt lgkmcnt(0)
  s_call_b64 s[62:63], L_bodyWV
  s_call_b64 s[62:63], L_bodyA0
  s_call_b64 s[62:63], L_bodyV
  s_call_b64 s[62:63], L_bodyV
  s_call_b64 s[62:63], L_bodyV
  s_call_b64 s[62:63], L_bodyV
  s_call_b64 s[62:63], L_bodyV
  s_xor_b32 s58, s60, 0x1000000
  s_call_b64 s[62:63], L_bodyV
  v_mov_b32 v57, v81
  s_nop 1
  v_permlane16_swap_b32 v81, v57
  v_add_f32 v81, v81, v57
  v_mov_b32 v57, v81
  s_nop 1
  v_permlane32_swap_b32 v81, v57
  v_add_f32 v81, v81, v57
  ds_write_b32 v6, v48 offset:1024
  ds_write_b32 v6, v49 offset:1056
  ds_write_b32 v6, v50 offset:1088
  ds_write_b32 v6, v51 offset:1120
  ds_write_b64 v7, v[80:81] offset:512
  v_xor_b32 v6, 0x800, v6
  v_xor_b32 v7, 32, v7
  v_mov_b32 v80, 0xf149f2ca
  v_mov_b32 v81, 0
  v_mov_b32 v48, 0
  v_mov_b32 v49, 0
  v_mov_b32 v50, 0
  v_mov_b32 v51, 0
  ds_read_b128 v[16:19], v88 offset:0
  ds_read_b128 v[20:23], v88 offset:64
  ds_read_b128 v[24:27], v88 offset:128
  ds_read_b128 v[28:31], v88 offset:192
  v_and_b32 v56, 7, v2
  v_lshlrev_b32 v89, 8, v56
  v_lshrrev_b32 v56, 3, v2
  v_lshl_add_u32 v89, v56, 6, v89
  v_lshl_add_u32 v89, v3, 4, v89
  v_and_b32 v56, 1, v2
  v_lshl_add_u32 v56, v56, 6, v88
  ds_read_b128 v[32:35], v56 offset:0
  ds_read_b128 v[36:39], v56 offset:128
  s_waitcnt lgkmcnt(0)
  s_call_b64 s[62:63], L_bodyV
  s_call_b64 s[62:63], L_bodyV
  s_call_b64 s[62:63], L_bodyV
  s_call_b64 s[62:63], L_bodyV
  s_call_b64 s[62:63], L_bodyV
  ds_read_b64_tr_b16 v[96:97], v95 offset:0
  ds_read_b64_tr_b16 v[98:99], v95 offset:256
  ds_read_b64_tr_b16 v[100:101], v95 offset:32
  ds_read_b64_tr_b16 v[102:103], v95 offset:288
  ds_read_b64_tr_b16 v[104:105], v95 offset:2048
  ds_read_b64_tr_b16 v[106:107], v95 offset:2304
  ds_read_b64_tr_b16 v[108:109], v95 offset:2080
  ds_read_b64_tr_b16 v[110:111], v95 offset:2336
  ds_read_b64_tr_b16 v[112:113], v95 offset:4096
  ds_read_b64_tr_b16 v[114:115], v95 offset:4352
  ds_read_b64_tr_b16 v[116:117], v95 offset:4128
  ds_read_b64_tr_b16 v[118:119], v95 offset:4384
  s_waitcnt lgkmcnt(8)
  ds_read_b64_tr_b16 v[120:121], v95 offset:6144
  ds_read_b64_tr_b16 v[122:123], v95 offset:6400
  ds_read_b64_tr_b16 v[124:125], v95 offset:6176
  ds_read_b64_tr_b16 v[126:127], v95 offset:6432
  s_call_b64 s[62:63], L_bodyVW
  buffer_load_dword v92, v85, s[48:51], 0 offen sc1
  s_call_b64 s[62:63], L_bodyWW
  s_mov_b32 s58, 0x20000000
  s_lshl_b32 s56, s79, 14
  s_lshl_b32 s55, s78, 11
  s_add_u32 s56, s56, s55
  s_add_u32 s56, s56, 0xa0000
  v_lshlrev_b32 v86, 11, v3
  v_lshl_add_u32 v86, v2, 1, v86
  s_and_b32 s60, s78, 3
  s_lshl_b32 s60, s60, 13
  s_lshl_b32 s55, s79, 6
  s_add_u32 s60, s60, s55
  s_lshr_b32 s55, s78, 2
  s_lshl_b32 s55, s55, 5
  s_add_u32 s60, s60, s55
  v_lshrrev_b32 v87, 5, v1
  v_and_b32 v88, 31, v1
  v_lshlrev_b32 v88, 4, v88
  v_lshl_add_u32 v88, v87, 11, v88
  v_lshlrev_b32 v87, 5, v87
  s_nop 0
  s_call_b64 s[62:63], L_bodyW
  v_mov_b32 v57, v81
  s_nop 1
  v_permlane16_swap_b32 v81, v57
  v_add_f32 v81, v81, v57
  v_mov_b32 v57, v81
  s_nop 1
  v_permlane32_swap_b32 v81, v57
  v_add_f32 v81, v81, v57
  ds_write_b32 v6, v48 offset:1024
  ds_write_b32 v6, v49 offset:1056
  ds_write_b32 v6, v50 offset:1088
  ds_write_b32 v6, v51 offset:1120
  ds_write_b64 v7, v[80:81] offset:512
  s_waitcnt lgkmcnt(0)
  s_barrier
  s_cmp_lg_u32 s54, 0
  s_cbranch_scc1 L_nocomb
  ds_read_b128 v[16:19], v87 offset:512
  ds_read_b128 v[20:23], v87 offset:528
  ds_read_b128 v[64:67], v88 offset:1024
  ds_read_b128 v[68:71], v88 offset:1536
  ds_read_b128 v[72:75], v88 offset:2048
  ds_read_b128 v[76:79], v88 offset:2560
  s_waitcnt lgkmcnt(4)
  v_max3_f32 v24, v16, v18, v20
  v_max_f32 v24, v24, v22
  v_sub_f32 v16, v16, v24
  v_sub_f32 v18, v18, v24
  v_sub_f32 v20, v20, v24
  v_sub_f32 v22, v22, v24
  v_exp_f32 v16, v16
  v_exp_f32 v18, v18
  v_exp_f32 v20, v20
  v_exp_f32 v22, v22
  v_mul_f32 v25, v16, v17
  v_fmac_f32 v25, v18, v19
  v_fmac_f32 v25, v20, v21
  v_fmac_f32 v25, v22, v23
  v_rcp_f32 v25, v25
  s_nop 0
  v_mul_f32 v16, v16, v25
  v_mul_f32 v18, v18, v25
  v_mul_f32 v20, v20, v25
  v_mul_f32 v22, v22, v25
  s_waitcnt lgkmcnt(0)
  v_mul_f32 v64, v64, v16
  v_mul_f32 v65, v65, v16
  v_mul_f32 v66, v66, v16
  v_mul_f32 v67, v67, v16
  v_fmac_f32 v64, v68, v18
  v_fmac_f32 v65, v69, v18
  v_fmac_f32 v66, v70, v18
  v_fmac_f32 v67, v71, v18
  v_fmac_f32 v64, v72, v20
  v_fmac_f32 v65, v73, v20
  v_fmac_f32 v66, v74, v20
  v_fmac_f32 v67, v75, v20
  v_fmac_f32 v64, v76, v22
  v_fmac_f32 v65, v77, v22
  v_fmac_f32 v66, v78, v22
  v_fmac_f32 v67, v79, v22
  v_cvt_pk_bf16_f32 v62, v64, v65
  v_cvt_pk_bf16_f32 v63, v66, v67
  buffer_store_dwordx2 v[62:63], v93, s[40:43], s67 offen sc1
  s_nop 0
L_nocomb:
  s_mov_b32 s69, 100000
  s_mov_b32 s55, 0x01010101
  s_waitcnt vmcnt(1)
L_fchk:
  v_cmp_ne_u32 vcc, s55, v92
  s_nop 3
  s_cbranch_vccz L_fok
  buffer_load_dword v92, v85, s[48:51], 0 offen sc1
  s_waitcnt vmcnt(0)
  s_sub_u32 s69, s69, 1
  s_cbranch_scc0 L_fchk
L_fok:
  buffer_load_dwordx4 v[16:19], v4, s[40:43], s61 offen offset:0 sc1
  buffer_load_dwordx4 v[20:23], v4, s[40:43], s61 offen offset:64 sc1
  buffer_load_dwordx4 v[24:27], v4, s[40:43], s61 offen offset:128 sc1
  buffer_load_dwordx4 v[28:31], v4, s[40:43], s61 offen offset:192 sc1
  s_mov_b32 s69, 100000
L_pollo:
  s_waitcnt vmcnt(0)
  v_max3_u32 v56, v16, v17, v18
  v_max3_u32 v57, v20, v21, v22
  v_max3_u32 v58, v24, v25, v26
  v_max3_u32 v59, v28, v29, v30
  v_max_u32 v56, v56, v19
  v_max_u32 v57, v57, v23
  v_max_u32 v58, v58, v27
  v_max_u32 v59, v59, v31
  v_cmp_eq_u32 s[70:71], -1, v56
  v_cmp_eq_u32 s[72:73], -1, v57
  v_cmp_eq_u32 s[74:75], -1, v58
  v_cmp_eq_u32 s[76:77], -1, v59
  s_or_b64 s[4:5], s[70:71], s[72:73]
  s_or_b64 s[6:7], s[74:75], s[76:77]
  s_or_b64 s[4:5], s[4:5], s[6:7]
  s_nop 0
  s_cbranch_scc0 L_pdoneo0
  s_or_b64 exec, s[70:71], 1
  buffer_load_dwordx4 v[16:19], v4, s[40:43], s61 offen offset:0 sc1
  s_or_b64 exec, s[72:73], 1
  buffer_load_dwordx4 v[20:23], v4, s[40:43], s61 offen offset:64 sc1
  s_or_b64 exec, s[74:75], 1
  buffer_load_dwordx4 v[24:27], v4, s[40:43], s61 offen offset:128 sc1
  s_or_b64 exec, s[76:77], 1
  buffer_load_dwordx4 v[28:31], v4, s[40:43], s61 offen offset:192 sc1
  s_mov_b64 exec, -1
  s_sub_u32 s69, s69, 1
  s_cbranch_scc0 L_pollo
  s_waitcnt vmcnt(0)
  s_branch L_pdoneo0
L_pdoneo0:
  v_mfma_f32_16x16x32_bf16 v[48:51], v[16:19], v[96:99], 0
  v_mfma_f32_16x16x32_bf16 v[52:55], v[16:19], v[100:103], 0
  v_mfma_f32_16x16x32_bf16 v[48:51], v[20:23], v[104:107], v[48:51]
  v_mfma_f32_16x16x32_bf16 v[52:55], v[20:23], v[108:111], v[52:55]
  v_mfma_f32_16x16x32_bf16 v[48:51], v[24:27], v[112:115], v[48:51]
  v_mfma_f32_16x16x32_bf16 v[52:55], v[24:27], v[116:119], v[52:55]
  v_mfma_f32_16x16x32_bf16 v[48:51], v[28:31], v[120:123], v[48:51]
  v_mfma_f32_16x16x32_bf16 v[52:55], v[28:31], v[124:127], v[52:55]
  s_nop 7
L_odone:
  ds_write_b128 v90, v[48:51] offset:5120
  ds_write_b128 v90, v[52:55] offset:6144
  s_waitcnt lgkmcnt(0)
  s_barrier
  s_cmp_lg_u32 s54, 0
  s_cbranch_scc1 L_end
  ds_read_b128 v[128:131], v82 offset:7168
  ds_read_b128 v[132:135], v82 offset:8192
  ds_read_b128 v[136:139], v82 offset:9216
  ds_read_b128 v[140:143], v82 offset:10240
  ds_read_b128 v[144:147], v82 offset:11264
  ds_read_b128 v[148:151], v82 offset:12288
  s_waitcnt lgkmcnt(0)
  v_add_f32 v48, v48, v128
  v_add_f32 v136, v136, v144
  v_add_f32 v49, v49, v129
  v_add_f32 v137, v137, v145
  v_add_f32 v50, v50, v130
  v_add_f32 v138, v138, v146
  v_add_f32 v51, v51, v131
  v_add_f32 v139, v139, v147
  v_add_f32 v52, v52, v132
  v_add_f32 v140, v140, v148
  v_add_f32 v53, v53, v133
  v_add_f32 v141, v141, v149
  v_add_f32 v54, v54, v134
  v_add_f32 v142, v142, v150
  v_add_f32 v55, v55, v135
  v_add_f32 v143, v143, v151
  v_add_f32 v48, v48, v136
  v_add_f32 v49, v49, v137
  v_add_f32 v50, v50, v138
  v_add_f32 v51, v51, v139
  v_add_f32 v52, v52, v140
  v_add_f32 v53, v53, v141
  v_add_f32 v54, v54, v142
  v_add_f32 v55, v55, v143
  buffer_store_dwordx4 v[48:51], v91, s[40:43], s66 offen sc1
  buffer_store_dwordx4 v[52:55], v91, s[40:43], s65 offen sc1
  buffer_load_dwordx4 v[96:99], v82, s[40:43], s56 offen offset:0 sc1
  buffer_load_dwordx4 v[100:103], v82, s[40:43], s56 offen offset:1024 sc1
  s_mov_b32 s69, 100000
L_pollg:
  s_waitcnt vmcnt(0)
  v_max3_u32 v56, v96, v97, v98
  v_max3_u32 v57, v100, v101, v102
  v_max_u32 v56, v56, v99
  v_max_u32 v57, v57, v103
  v_cmp_eq_u32 s[70:71], -1, v56
  v_cmp_eq_u32 s[72:73], -1, v57
  s_nop 0
  s_or_b64 s[4:5], s[70:71], s[72:73]
  s_nop 1
  s_cbranch_scc0 L_pdoneg0
  s_or_b64 exec, s[70:71], 1
  buffer_load_dwordx4 v[96:99], v82, s[40:43], s56 offen offset:0 sc1
  s_or_b64 exec, s[72:73], 1
  buffer_load_dwordx4 v[100:103], v82, s[40:43], s56 offen offset:1024 sc1
  s_mov_b64 exec, -1
  s_sub_u32 s69, s69, 1
  s_cbranch_scc0 L_pollg
  s_waitcnt vmcnt(0)
  s_branch L_pdoneg0
L_pdoneg0:
  v_add_f32 v64, v96, v100
  v_add_f32 v65, v97, v101
  v_add_f32 v66, v98, v102
  v_add_f32 v67, v99, v103
  s_nop 1
L_gdone:
  v_permlane32_swap_b32 v64, v66
  v_permlane32_swap_b32 v65, v67
  v_add_f32 v64, v64, v66
  v_add_f32 v65, v65, v67
  s_nop 1
  v_permlane16_swap_b32 v64, v65
  v_add_f32 v64, v64, v65
  v_cvt_pk_bf16_f32 v64, v64, v64
  buffer_store_short v64, v86, s[44:47], s60 offen
  s_nop 0
L_end:
  s_endpgm
L_bodyV:
  s_waitcnt vmcnt(28)
  v_mfma_f32_16x16x32_bf16 v[52:55], v[128:131], v[16:19], 0
  v_mfma_f32_16x16x32_bf16 v[52:55], v[132:135], v[20:23], v[52:55]
  v_mfma_f32_16x16x32_bf16 v[52:55], v[136:139], v[24:27], v[52:55]
  v_mfma_f32_16x16x32_bf16 v[52:55], v[140:143], v[28:31], v[52:55]
  buffer_load_dwordx4 v[128:131], v4, s[20:23], s58 offen offset:0 nt
  buffer_load_dwordx4 v[132:135], v4, s[20:23], s58 offen offset:64 nt
  buffer_load_dwordx4 v[136:139], v4, s[20:23], s58 offen offset:128 nt
  buffer_load_dwordx4 v[140:143], v4, s[20:23], s58 offen offset:192 nt
  s_nop 3
  v_max3_f32 v56, v52, v53, v54
  v_max_f32 v56, v56, v55
  v_mov_b32 v57, v56
  s_nop 1
  v_permlane16_swap_b32 v56, v57
  v_max_f32 v56, v56, v57
  v_mov_b32 v57, v56
  s_nop 1
  v_permlane32_swap_b32 v56, v57
  v_max_f32 v56, v56, v57
  v_mul_f32 v56, s59, v56
  v_max_f32 v56, v56, v80
  v_sub_f32 v57, v80, v56
  v_mov_b32 v80, v56
  v_exp_f32 v57, v57
  v_fma_f32 v58, v52, s59, -v56
  v_fma_f32 v59, v53, s59, -v56
  v_fma_f32 v60, v54, s59, -v56
  v_fma_f32 v61, v55, s59, -v56
  v_exp_f32 v58, v58
  v_exp_f32 v59, v59
  v_exp_f32 v60, v60
  v_exp_f32 v61, v61
  v_mul_f32 v48, v48, v57
  v_mul_f32 v49, v49, v57
  v_mul_f32 v50, v50, v57
  v_mul_f32 v51, v51, v57
  v_cvt_pk_bf16_f32 v62, v58, v59
  v_cvt_pk_bf16_f32 v63, v60, v61
  v_add_f32 v58, v58, v59
  v_add_f32 v60, v60, v61
  v_add_f32 v58, v58, v60
  v_fma_f32 v81, v81, v57, v58
  v_perm_b32 v64, v62, v62, v8
  v_perm_b32 v65, v62, v62, v9
  v_perm_b32 v66, v62, v62, v10
  v_perm_b32 v67, v62, v62, v11
  v_perm_b32 v68, v62, v62, v12
  v_perm_b32 v69, v62, v62, v13
  v_perm_b32 v70, v62, v62, v14
  v_perm_b32 v71, v62, v62, v15
  v_perm_b32 v72, v63, v63, v8
  v_perm_b32 v73, v63, v63, v9
  v_perm_b32 v74, v63, v63, v10
  v_perm_b32 v75, v63, v63, v11
  v_perm_b32 v76, v63, v63, v12
  v_perm_b32 v77, v63, v63, v13
  v_perm_b32 v78, v63, v63, v14
  v_perm_b32 v79, v63, v63, v15
  s_waitcnt vmcnt(28)
  v_mfma_f32_16x16x32_bf16 v[48:51], v[144:147], v[64:67], v[48:51]
  v_mfma_f32_16x16x32_bf16 v[48:51], v[148:151], v[68:71], v[48:51]
  v_mfma_f32_16x16x32_bf16 v[48:51], v[152:155], v[72:75], v[48:51]
  v_mfma_f32_16x16x32_bf16 v[48:51], v[156:159], v[76:79], v[48:51]
  buffer_load_dwordx4 v[144:147], v5, s[24:27], s58 offen offset:0 nt
  buffer_load_dwordx4 v[148:151], v5, s[24:27], s58 offen offset:256 nt
  buffer_load_dwordx4 v[152:155], v5, s[24:27], s58 offen offset:512 nt
  buffer_load_dwordx4 v[156:159], v5, s[24:27], s58 offen offset:768 nt
  s_add_u32 s58, s58, 0x4000
  s_waitcnt vmcnt(28)
  v_mfma_f32_16x16x32_bf16 v[52:55], v[160:163], v[16:19], 0
  v_mfma_f32_16x16x32_bf16 v[52:55], v[164:167], v[20:23], v[52:55]
  v_mfma_f32_16x16x32_bf16 v[52:55], v[168:171], v[24:27], v[52:55]
  v_mfma_f32_16x16x32_bf16 v[52:55], v[172:175], v[28:31], v[52:55]
  buffer_load_dwordx4 v[160:163], v4, s[20:23], s58 offen offset:0 nt
  buffer_load_dwordx4 v[164:167], v4, s[20:23], s58 offen offset:64 nt
  buffer_load_dwordx4 v[168:171], v4, s[20:23], s58 offen offset:128 nt
  buffer_load_dwordx4 v[172:175], v4, s[20:23], s58 offen offset:192 nt
  s_nop 3
  v_max3_f32 v56, v52, v53, v54
  v_max_f32 v56, v56, v55
  v_mov_b32 v57, v56
  s_nop 1
  v_permlane16_swap_b32 v56, v57
  v_max_f32 v56, v56, v57
  v_mov_b32 v57, v56
  s_nop 1
  v_permlane32_swap_b32 v56, v57
  v_max_f32 v56, v56, v57
  v_mul_f32 v56, s59, v56
  v_max_f32 v56, v56, v80
  v_sub_f32 v57, v80, v56
  v_mov_b32 v80, v56
  v_exp_f32 v57, v57
  v_fma_f32 v58, v52, s59, -v56
  v_fma_f32 v59, v53, s59, -v56
  v_fma_f32 v60, v54, s59, -v56
  v_fma_f32 v61, v55, s59, -v56
  v_exp_f32 v58, v58
  v_exp_f32 v59, v59
  v_exp_f32 v60, v60
  v_exp_f32 v61, v61
  v_mul_f32 v48, v48, v57
  v_mul_f32 v49, v49, v57
  v_mul_f32 v50, v50, v57
  v_mul_f32 v51, v51, v57
  v_cvt_pk_bf16_f32 v62, v58, v59
  v_cvt_pk_bf16_f32 v63, v60, v61
  v_add_f32 v58, v58, v59
  v_add_f32 v60, v60, v61
  v_add_f32 v58, v58, v60
  v_fma_f32 v81, v81, v57, v58
  v_perm_b32 v64, v62, v62, v8
  v_perm_b32 v65, v62, v62, v9
  v_perm_b32 v66, v62, v62, v10
  v_perm_b32 v67, v62, v62, v11
  v_perm_b32 v68, v62, v62, v12
  v_perm_b32 v69, v62, v62, v13
  v_perm_b32 v70, v62, v62, v14
  v_perm_b32 v71, v62, v62, v15
  v_perm_b32 v72, v63, v63, v8
  v_perm_b32 v73, v63, v63, v9
  v_perm_b32 v74, v63, v63, v10
  v_perm_b32 v75, v63, v63, v11
  v_perm_b32 v76, v63, v63, v12
  v_perm_b32 v77, v63, v63, v13
  v_perm_b32 v78, v63, v63, v14
  v_perm_b32 v79, v63, v63, v15
  s_waitcnt vmcnt(28)
  v_mfma_f32_16x16x32_bf16 v[48:51], v[176:179], v[64:67], v[48:51]
  v_mfma_f32_16x16x32_bf16 v[48:51], v[180:183], v[68:71], v[48:51]
  v_mfma_f32_16x16x32_bf16 v[48:51], v[184:187], v[72:75], v[48:51]
  v_mfma_f32_16x16x32_bf16 v[48:51], v[188:191], v[76:79], v[48:51]
  buffer_load_dwordx4 v[176:179], v5, s[24:27], s58 offen offset:0 nt
  buffer_load_dwordx4 v[180:183], v5, s[24:27], s58 offen offset:256 nt
  buffer_load_dwordx4 v[184:187], v5, s[24:27], s58 offen offset:512 nt
  buffer_load_dwordx4 v[188:191], v5, s[24:27], s58 offen offset:768 nt
  s_add_u32 s58, s58, 0x4000
  s_waitcnt vmcnt(28)
  v_mfma_f32_16x16x32_bf16 v[52:55], v[192:195], v[16:19], 0
  v_mfma_f32_16x16x32_bf16 v[52:55], v[196:199], v[20:23], v[52:55]
  v_mfma_f32_16x16x32_bf16 v[52:55], v[200:203], v[24:27], v[52:55]
  v_mfma_f32_16x16x32_bf16 v[52:55], v[204:207], v[28:31], v[52:55]
  buffer_load_dwordx4 v[192:195], v4, s[20:23], s58 offen offset:0 nt
  buffer_load_dwordx4 v[196:199], v4, s[20:23], s58 offen offset:64 nt
  buffer_load_dwordx4 v[200:203], v4, s[20:23], s58 offen offset:128 nt
  buffer_load_dwordx4 v[204:207], v4, s[20:23], s58 offen offset:192 nt
  s_nop 3
  v_max3_f32 v56, v52, v53, v54
  v_max_f32 v56, v56, v55
  v_mov_b32 v57, v56
  s_nop 1
  v_permlane16_swap_b32 v56, v57
  v_max_f32 v56, v56, v57
  v_mov_b32 v57, v56
  s_nop 1
  v_permlane32_swap_b32 v56, v57
  v_max_f32 v56, v56, v57
  v_mul_f32 v56, s59, v56
  v_max_f32 v56, v56, v80
  v_sub_f32 v57, v80, v56
  v_mov_b32 v80, v56
  v_exp_f32 v57, v57
  v_fma_f32 v58, v52, s59, -v56
  v_fma_f32 v59, v53, s59, -v56
  v_fma_f32 v60, v54, s59, -v56
  v_fma_f32 v61, v55, s59, -v56
  v_exp_f32 v58, v58
  v_exp_f32 v59, v59
  v_exp_f32 v60, v60
  v_exp_f32 v61, v61
  v_mul_f32 v48, v48, v57
  v_mul_f32 v49, v49, v57
  v_mul_f32 v50, v50, v57
  v_mul_f32 v51, v51, v57
  v_cvt_pk_bf16_f32 v62, v58, v59
  v_cvt_pk_bf16_f32 v63, v60, v61
  v_add_f32 v58, v58, v59
  v_add_f32 v60, v60, v61
  v_add_f32 v58, v58, v60
  v_fma_f32 v81, v81, v57, v58
  v_perm_b32 v64, v62, v62, v8
  v_perm_b32 v65, v62, v62, v9
  v_perm_b32 v66, v62, v62, v10
  v_perm_b32 v67, v62, v62, v11
  v_perm_b32 v68, v62, v62, v12
  v_perm_b32 v69, v62, v62, v13
  v_perm_b32 v70, v62, v62, v14
  v_perm_b32 v71, v62, v62, v15
  v_perm_b32 v72, v63, v63, v8
  v_perm_b32 v73, v63, v63, v9
  v_perm_b32 v74, v63, v63, v10
  v_perm_b32 v75, v63, v63, v11
  v_perm_b32 v76, v63, v63, v12
  v_perm_b32 v77, v63, v63, v13
  v_perm_b32 v78, v63, v63, v14
  v_perm_b32 v79, v63, v63, v15
  s_waitcnt vmcnt(28)
  v_mfma_f32_16x16x32_bf16 v[48:51], v[208:211], v[64:67], v[48:51]
  v_mfma_f32_16x16x32_bf16 v[48:51], v[212:215], v[68:71], v[48:51]
  v_mfma_f32_16x16x32_bf16 v[48:51], v[216:219], v[72:75], v[48:51]
  v_mfma_f32_16x16x32_bf16 v[48:51], v[220:223], v[76:79], v[48:51]
  buffer_load_dwordx4 v[208:211], v5, s[24:27], s58 offen offset:0 nt
  buffer_load_dwordx4 v[212:215], v5, s[24:27], s58 offen offset:256 nt
  buffer_load_dwordx4 v[216:219], v5, s[24:27], s58 offen offset:512 nt
  buffer_load_dwordx4 v[220:223], v5, s[24:27], s58 offen offset:768 nt
  s_add_u32 s58, s58, 0x4000
  s_waitcnt vmcnt(28)
  v_mfma_f32_16x16x32_bf16 v[52:55], v[224:227], v[16:19], 0
  v_mfma_f32_16x16x32_bf16 v[52:55], v[228:231], v[20:23], v[52:55]
  v_mfma_f32_16x16x32_bf16 v[52:55], v[232:235], v[24:27], v[52:55]
  v_mfma_f32_16x16x32_bf16 v[52:55], v[236:239], v[28:31], v[52:55]
  buffer_load_dwordx4 v[224:227], v4, s[20:23], s58 offen offset:0 nt
  buffer_load_dwordx4 v[228:231], v4, s[20:23], s58 offen offset:64 nt
  buffer_load_dwordx4 v[232:235], v4, s[20:23], s58 offen offset:128 nt
  buffer_load_dwordx4 v[236:239], v4, s[20:23], s58 offen offset:192 nt
  s_nop 3
  v_max3_f32 v56, v52, v53, v54
  v_max_f32 v56, v56, v55
  v_mov_b32 v57, v56
  s_nop 1
  v_permlane16_swap_b32 v56, v57
  v_max_f32 v56, v56, v57
  v_mov_b32 v57, v56
  s_nop 1
  v_permlane32_swap_b32 v56, v57
  v_max_f32 v56, v56, v57
  v_mul_f32 v56, s59, v56
  v_max_f32 v56, v56, v80
  v_sub_f32 v57, v80, v56
  v_mov_b32 v80, v56
  v_exp_f32 v57, v57
  v_fma_f32 v58, v52, s59, -v56
  v_fma_f32 v59, v53, s59, -v56
  v_fma_f32 v60, v54, s59, -v56
  v_fma_f32 v61, v55, s59, -v56
  v_exp_f32 v58, v58
  v_exp_f32 v59, v59
  v_exp_f32 v60, v60
  v_exp_f32 v61, v61
  v_mul_f32 v48, v48, v57
  v_mul_f32 v49, v49, v57
  v_mul_f32 v50, v50, v57
  v_mul_f32 v51, v51, v57
  v_cvt_pk_bf16_f32 v62, v58, v59
  v_cvt_pk_bf16_f32 v63, v60, v61
  v_add_f32 v58, v58, v59
  v_add_f32 v60, v60, v61
  v_add_f32 v58, v58, v60
  v_fma_f32 v81, v81, v57, v58
  v_perm_b32 v64, v62, v62, v8
  v_perm_b32 v65, v62, v62, v9
  v_perm_b32 v66, v62, v62, v10
  v_perm_b32 v67, v62, v62, v11
  v_perm_b32 v68, v62, v62, v12
  v_perm_b32 v69, v62, v62, v13
  v_perm_b32 v70, v62, v62, v14
  v_perm_b32 v71, v62, v62, v15
  v_perm_b32 v72, v63, v63, v8
  v_perm_b32 v73, v63, v63, v9
  v_perm_b32 v74, v63, v63, v10
  v_perm_b32 v75, v63, v63, v11
  v_perm_b32 v76, v63, v63, v12
  v_perm_b32 v77, v63, v63, v13
  v_perm_b32 v78, v63, v63, v14
  v_perm_b32 v79, v63, v63, v15
  s_waitcnt vmcnt(28)
  v_mfma_f32_16x16x32_bf16 v[48:51], v[240:243], v[64:67], v[48:51]
  v_mfma_f32_16x16x32_bf16 v[48:51], v[244:247], v[68:71], v[48:51]
  v_mfma_f32_16x16x32_bf16 v[48:51], v[248:251], v[72:75], v[48:51]
  v_mfma_f32_16x16x32_bf16 v[48:51], v[252:255], v[76:79], v[48:51]
  buffer_load_dwordx4 v[240:243], v5, s[24:27], s58 offen offset:0 nt
  buffer_load_dwordx4 v[244:247], v5, s[24:27], s58 offen offset:256 nt
  buffer_load_dwordx4 v[248:251], v5, s[24:27], s58 offen offset:512 nt
  buffer_load_dwordx4 v[252:255], v5, s[24:27], s58 offen offset:768 nt
  s_add_u32 s58, s58, 0x4000
  s_nop 1
  s_setpc_b64 s[62:63]
L_bodyWV:
  s_waitcnt vmcnt(28)
  v_mfma_f32_16x16x32_bf16 v[52:55], v[128:131], v[32:35], 0
  v_mfma_f32_16x16x32_bf16 v[58:61], v[136:139], v[32:35], 0
  v_mfma_f32_16x16x32_bf16 v[52:55], v[132:135], v[36:39], v[52:55]
  v_mfma_f32_16x16x32_bf16 v[58:61], v[140:143], v[36:39], v[58:61]
  buffer_load_dwordx4 v[128:131], v4, s[20:23], s58 offen offset:0 nt
  buffer_load_dwordx4 v[132:135], v4, s[20:23], s58 offen offset:64 nt
  buffer_load_dwordx4 v[136:139], v4, s[20:23], s58 offen offset:128 nt
  buffer_load_dwordx4 v[140:143], v4, s[20:23], s58 offen offset:192 nt
  s_nop 3
  v_permlane32_swap_b32 v52, v58
  v_permlane32_swap_b32 v53, v59
  v_permlane32_swap_b32 v54, v60
  v_permlane32_swap_b32 v55, v61
  v_mov_b32_dpp v58, v58 quad_perm:[1,1,3,3] row_mask:0xf bank_mask:0xf
  v_mov_b32_dpp v59, v59 quad_perm:[1,1,3,3] row_mask:0xf bank_mask:0xf
  v_mov_b32_dpp v60, v60 quad_perm:[1,1,3,3] row_mask:0xf bank_mask:0xf
  v_mov_b32_dpp v61, v61 quad_perm:[1,1,3,3] row_mask:0xf bank_mask:0xf
  v_add_f32_dpp v52, v52, v58 quad_perm:[0,0,2,2] row_mask:0xf bank_mask:0xf
  v_add_f32_dpp v53, v53, v59 quad_perm:[0,0,2,2] row_mask:0xf bank_mask:0xf
  v_add_f32_dpp v54, v54, v60 quad_perm:[0,0,2,2] row_mask:0xf bank_mask:0xf
  v_add_f32_dpp v55, v55, v61 quad_perm:[0,0,2,2] row_mask:0xf bank_mask:0xf
  v_max3_f32 v56, v52, v53, v54
  v_max_f32 v56, v56, v55
  v_mov_b32 v57, v56
  s_nop 1
  v_permlane16_swap_b32 v56, v57
  v_max_f32 v56, v56, v57
  v_mov_b32 v57, v56
  s_nop 1
  v_permlane32_swap_b32 v56, v57
  v_max_f32 v56, v56, v57
  v_mul_f32 v56, s59, v56
  v_max_f32 v56, v56, v80
  v_sub_f32 v57, v80, v56
  v_mov_b32 v80, v56
  v_exp_f32 v57, v57
  v_fma_f32 v58, v52, s59, -v56
  v_fma_f32 v59, v53, s59, -v56
  v_fma_f32 v60, v54, s59, -v56
  v_fma_f32 v61, v55, s59, -v56
  v_exp_f32 v58, v58
  v_exp_f32 v59, v59
  v_exp_f32 v60, v60
  v_exp_f32 v61, v61
  v_mul_f32 v48, v48, v57
  v_mul_f32 v49, v49, v57
  v_mul_f32 v50, v50, v57
  v_mul_f32 v51, v51, v57
  v_cvt_pk_bf16_f32 v62, v58, v59
  v_cvt_pk_bf16_f32 v63, v60, v61
  v_add_f32 v58, v58, v59
  v_add_f32 v60, v60, v61
  v_add_f32 v58, v58, v60
  v_fma_f32 v81, v81, v57, v58
  v_perm_b32 v64, v62, v62, v8
  v_perm_b32 v65, v62, v62, v9
  v_perm_b32 v66, v62, v62, v10
  v_perm_b32 v67, v62, v62, v11
  v_perm_b32 v68, v62, v62, v12
  v_perm_b32 v69, v62, v62, v13
  v_perm_b32 v70, v62, v62, v14
  v_perm_b32 v71, v62, v62, v15
  v_perm_b32 v72, v63, v63, v8
  v_perm_b32 v73, v63, v63, v9
  v_perm_b32 v74, v63, v63, v10
  v_perm_b32 v75, v63, v63, v11
  v_perm_b32 v76, v63, v63, v12
  v_perm_b32 v77, v63, v63, v13
  v_perm_b32 v78, v63, v63, v14
  v_perm_b32 v79, v63, v63, v15
  s_waitcnt vmcnt(28)
  v_mfma_f32_16x16x32_bf16 v[48:51], v[144:147], v[64:67], v[48:51]
  v_mfma_f32_16x16x32_bf16 v[48:51], v[148:151], v[68:71], v[48:51]
  v_mfma_f32_16x16x32_bf16 v[48:51], v[152:155], v[72:75], v[48:51]
  v_mfma_f32_16x16x32_bf16 v[48:51], v[156:159], v[76:79], v[48:51]
  buffer_load_dwordx4 v[144:147], v5, s[24:27], s58 offen offset:0 nt
  buffer_load_dwordx4 v[148:151], v5, s[24:27], s58 offen offset:256 nt
  buffer_load_dwordx4 v[152:155], v5, s[24:27], s58 offen offset:512 nt
  buffer_load_dwordx4 v[156:159], v5, s[24:27], s58 offen offset:768 nt
  s_add_u32 s58, s58, 0x4000
  s_waitcnt vmcnt(28)
  v_mfma_f32_16x16x32_bf16 v[52:55], v[160:163], v[32:35], 0
  v_mfma_f32_16x16x32_bf16 v[58:61], v[168:171], v[32:35], 0
  v_mfma_f32_16x16x32_bf16 v[52:55], v[164:167], v[36:39], v[52:55]
  v_mfma_f32_16x16x32_bf16 v[58:61], v[172:175], v[36:39], v[58:61]
  buffer_load_dwordx4 v[160:163], v4, s[20:23], s58 offen offset:0 nt
  buffer_load_dwordx4 v[164:167], v4, s[20:23], s58 offen offset:64 nt
  buffer_load_dwordx4 v[168:171], v4, s[20:23], s58 offen offset:128 nt
  buffer_load_dwordx4 v[172:175], v4, s[20:23], s58 offen offset:192 nt
  s_nop 3
  v_permlane32_swap_b32 v52, v58
  v_permlane32_swap_b32 v53, v59
  v_permlane32_swap_b32 v54, v60
  v_permlane32_swap_b32 v55, v61
  v_mov_b32_dpp v58, v58 quad_perm:[1,1,3,3] row_mask:0xf bank_mask:0xf
  v_mov_b32_dpp v59, v59 quad_perm:[1,1,3,3] row_mask:0xf bank_mask:0xf
  v_mov_b32_dpp v60, v60 quad_perm:[1,1,3,3] row_mask:0xf bank_mask:0xf
  v_mov_b32_dpp v61, v61 quad_perm:[1,1,3,3] row_mask:0xf bank_mask:0xf
  v_add_f32_dpp v52, v52, v58 quad_perm:[0,0,2,2] row_mask:0xf bank_mask:0xf
  v_add_f32_dpp v53, v53, v59 quad_perm:[0,0,2,2] row_mask:0xf bank_mask:0xf
  v_add_f32_dpp v54, v54, v60 quad_perm:[0,0,2,2] row_mask:0xf bank_mask:0xf
  v_add_f32_dpp v55, v55, v61 quad_perm:[0,0,2,2] row_mask:0xf bank_mask:0xf
  v_max3_f32 v56, v52, v53, v54
  v_max_f32 v56, v56, v55
  v_mov_b32 v57, v56
  s_nop 1
  v_permlane16_swap_b32 v56, v57
  v_max_f32 v56, v56, v57
  v_mov_b32 v57, v56
  s_nop 1
  v_permlane32_swap_b32 v56, v57
  v_max_f32 v56, v56, v57
  v_mul_f32 v56, s59, v56
  v_max_f32 v56, v56, v80
  v_sub_f32 v57, v80, v56
  v_mov_b32 v80, v56
  v_exp_f32 v57, v57
  v_fma_f32 v58, v52, s59, -v56
  v_fma_f32 v59, v53, s59, -v56
  v_fma_f32 v60, v54, s59, -v56
  v_fma_f32 v61, v55, s59, -v56
  v_exp_f32 v58, v58
  v_exp_f32 v59, v59
  v_exp_f32 v60, v60
  v_exp_f32 v61, v61
  v_mul_f32 v48, v48, v57
  v_mul_f32 v49, v49, v57
  v_mul_f32 v50, v50, v57
  v_mul_f32 v51, v51, v57
  v_cvt_pk_bf16_f32 v62, v58, v59
  v_cvt_pk_bf16_f32 v63, v60, v61
  v_add_f32 v58, v58, v59
  v_add_f32 v60, v60, v61
  v_add_f32 v58, v58, v60
  v_fma_f32 v81, v81, v57, v58
  v_perm_b32 v64, v62, v62, v8
  v_perm_b32 v65, v62, v62, v9
  v_perm_b32 v66, v62, v62, v10
  v_perm_b32 v67, v62, v62, v11
  v_perm_b32 v68, v62, v62, v12
  v_perm_b32 v69, v62, v62, v13
  v_perm_b32 v70, v62, v62, v14
  v_perm_b32 v71, v62, v62, v15
  v_perm_b32 v72, v63, v63, v8
  v_perm_b32 v73, v63, v63, v9
  v_perm_b32 v74, v63, v63, v10
  v_perm_b32 v75, v63, v63, v11
  v_perm_b32 v76, v63, v63, v12
  v_perm_b32 v77, v63, v63, v13
  v_perm_b32 v78, v63, v63, v14
  v_perm_b32 v79, v63, v63, v15
  s_waitcnt vmcnt(28)
  v_mfma_f32_16x16x32_bf16 v[48:51], v[176:179], v[64:67], v[48:51]
  v_mfma_f32_16x16x32_bf16 v[48:51], v[180:183], v[68:71], v[48:51]
  v_mfma_f32_16x16x32_bf16 v[48:51], v[184:187], v[72:75], v[48:51]
  v_mfma_f32_16x16x32_bf16 v[48:51], v[188:191], v[76:79], v[48:51]
  buffer_load_dwordx4 v[176:179], v5, s[24:27], s58 offen offset:0 nt
  buffer_load_dwordx4 v[180:183], v5, s[24:27], s58 offen offset:256 nt
  buffer_load_dwordx4 v[184:187], v5, s[24:27], s58 offen offset:512 nt
  buffer_load_dwordx4 v[188:191], v5, s[24:27], s58 offen offset:768 nt
  s_add_u32 s58, s58, 0x4000
  s_waitcnt vmcnt(28)
  v_mfma_f32_16x16x32_bf16 v[52:55], v[192:195], v[32:35], 0
  v_mfma_f32_16x16x32_bf16 v[58:61], v[200:203], v[32:35], 0
  v_mfma_f32_16x16x32_bf16 v[52:55], v[196:199], v[36:39], v[52:55]
  v_mfma_f32_16x16x32_bf16 v[58:61], v[204:207], v[36:39], v[58:61]
  buffer_load_dwordx4 v[192:195], v4, s[20:23], s58 offen offset:0 nt
  buffer_load_dwordx4 v[196:199], v4, s[20:23], s58 offen offset:64 nt
  buffer_load_dwordx4 v[200:203], v4, s[20:23], s58 offen offset:128 nt
  buffer_load_dwordx4 v[204:207], v4, s[20:23], s58 offen offset:192 nt
  s_nop 3
  v_permlane32_swap_b32 v52, v58
  v_permlane32_swap_b32 v53, v59
  v_permlane32_swap_b32 v54, v60
  v_permlane32_swap_b32 v55, v61
  v_mov_b32_dpp v58, v58 quad_perm:[1,1,3,3] row_mask:0xf bank_mask:0xf
  v_mov_b32_dpp v59, v59 quad_perm:[1,1,3,3] row_mask:0xf bank_mask:0xf
  v_mov_b32_dpp v60, v60 quad_perm:[1,1,3,3] row_mask:0xf bank_mask:0xf
  v_mov_b32_dpp v61, v61 quad_perm:[1,1,3,3] row_mask:0xf bank_mask:0xf
  v_add_f32_dpp v52, v52, v58 quad_perm:[0,0,2,2] row_mask:0xf bank_mask:0xf
  v_add_f32_dpp v53, v53, v59 quad_perm:[0,0,2,2] row_mask:0xf bank_mask:0xf
  v_add_f32_dpp v54, v54, v60 quad_perm:[0,0,2,2] row_mask:0xf bank_mask:0xf
  v_add_f32_dpp v55, v55, v61 quad_perm:[0,0,2,2] row_mask:0xf bank_mask:0xf
  v_max3_f32 v56, v52, v53, v54
  v_max_f32 v56, v56, v55
  v_mov_b32 v57, v56
  s_nop 1
  v_permlane16_swap_b32 v56, v57
  v_max_f32 v56, v56, v57
  v_mov_b32 v57, v56
  s_nop 1
  v_permlane32_swap_b32 v56, v57
  v_max_f32 v56, v56, v57
  v_mul_f32 v56, s59, v56
  v_max_f32 v56, v56, v80
  v_sub_f32 v57, v80, v56
  v_mov_b32 v80, v56
  v_exp_f32 v57, v57
  v_fma_f32 v58, v52, s59, -v56
  v_fma_f32 v59, v53, s59, -v56
  v_fma_f32 v60, v54, s59, -v56
  v_fma_f32 v61, v55, s59, -v56
  v_exp_f32 v58, v58
  v_exp_f32 v59, v59
  v_exp_f32 v60, v60
  v_exp_f32 v61, v61
  v_mul_f32 v48, v48, v57
  v_mul_f32 v49, v49, v57
  v_mul_f32 v50, v50, v57
  v_mul_f32 v51, v51, v57
  v_cvt_pk_bf16_f32 v62, v58, v59
  v_cvt_pk_bf16_f32 v63, v60, v61
  v_add_f32 v58, v58, v59
  v_add_f32 v60, v60, v61
  v_add_f32 v58, v58, v60
  v_fma_f32 v81, v81, v57, v58
  v_perm_b32 v64, v62, v62, v8
  v_perm_b32 v65, v62, v62, v9
  v_perm_b32 v66, v62, v62, v10
  v_perm_b32 v67, v62, v62, v11
  v_perm_b32 v68, v62, v62, v12
  v_perm_b32 v69, v62, v62, v13
  v_perm_b32 v70, v62, v62, v14
  v_perm_b32 v71, v62, v62, v15
  v_perm_b32 v72, v63, v63, v8
  v_perm_b32 v73, v63, v63, v9
  v_perm_b32 v74, v63, v63, v10
  v_perm_b32 v75, v63, v63, v11
  v_perm_b32 v76, v63, v63, v12
  v_perm_b32 v77, v63, v63, v13
  v_perm_b32 v78, v63, v63, v14
  v_perm_b32 v79, v63, v63, v15
  s_waitcnt vmcnt(28)
  v_mfma_f32_16x16x32_bf16 v[48:51], v[208:211], v[64:67], v[48:51]
  v_mfma_f32_16x16x32_bf16 v[48:51], v[212:215], v[68:71], v[48:51]
  v_mfma_f32_16x16x32_bf16 v[48:51], v[216:219], v[72:75], v[48:51]
  v_mfma_f32_16x16x32_bf16 v[48:51], v[220:223], v[76:79], v[48:51]
  buffer_load_dwordx4 v[208:211], v5, s[24:27], s58 offen offset:0 nt
  buffer_load_dwordx4 v[212:215], v5, s[24:27], s58 offen offset:256 nt
  buffer_load_dwordx4 v[216:219], v5, s[24:27], s58 offen offset:512 nt
  buffer_load_dwordx4 v[220:223], v5, s[24:27], s58 offen offset:768 nt
  s_add_u32 s58, s58, 0x4000
  s_waitcnt vmcnt(28)
  v_mfma_f32_16x16x32_bf16 v[52:55], v[224:227], v[32:35], 0
  v_mfma_f32_16x16x32_bf16 v[58:61], v[232:235], v[32:35], 0
  v_mfma_f32_16x16x32_bf16 v[52:55], v[228:231], v[36:39], v[52:55]
  v_mfma_f32_16x16x32_bf16 v[58:61], v[236:239], v[36:39], v[58:61]
  buffer_load_dwordx4 v[224:227], v4, s[20:23], s58 offen offset:0 nt
  buffer_load_dwordx4 v[228:231], v4, s[20:23], s58 offen offset:64 nt
  buffer_load_dwordx4 v[232:235], v4, s[20:23], s58 offen offset:128 nt
  buffer_load_dwordx4 v[236:239], v4, s[20:23], s58 offen offset:192 nt
  s_nop 3
  v_permlane32_swap_b32 v52, v58
  v_permlane32_swap_b32 v53, v59
  v_permlane32_swap_b32 v54, v60
  v_permlane32_swap_b32 v55, v61
  v_mov_b32_dpp v58, v58 quad_perm:[1,1,3,3] row_mask:0xf bank_mask:0xf
  v_mov_b32_dpp v59, v59 quad_perm:[1,1,3,3] row_mask:0xf bank_mask:0xf
  v_mov_b32_dpp v60, v60 quad_perm:[1,1,3,3] row_mask:0xf bank_mask:0xf
  v_mov_b32_dpp v61, v61 quad_perm:[1,1,3,3] row_mask:0xf bank_mask:0xf
  v_add_f32_dpp v52, v52, v58 quad_perm:[0,0,2,2] row_mask:0xf bank_mask:0xf
  v_add_f32_dpp v53, v53, v59 quad_perm:[0,0,2,2] row_mask:0xf bank_mask:0xf
  v_add_f32_dpp v54, v54, v60 quad_perm:[0,0,2,2] row_mask:0xf bank_mask:0xf
  v_add_f32_dpp v55, v55, v61 quad_perm:[0,0,2,2] row_mask:0xf bank_mask:0xf
  v_max3_f32 v56, v52, v53, v54
  v_max_f32 v56, v56, v55
  v_mov_b32 v57, v56
  s_nop 1
  v_permlane16_swap_b32 v56, v57
  v_max_f32 v56, v56, v57
  v_mov_b32 v57, v56
  s_nop 1
  v_permlane32_swap_b32 v56, v57
  v_max_f32 v56, v56, v57
  v_mul_f32 v56, s59, v56
  v_max_f32 v56, v56, v80
  v_sub_f32 v57, v80, v56
  v_mov_b32 v80, v56
  v_exp_f32 v57, v57
  v_fma_f32 v58, v52, s59, -v56
  v_fma_f32 v59, v53, s59, -v56
  v_fma_f32 v60, v54, s59, -v56
  v_fma_f32 v61, v55, s59, -v56
  v_exp_f32 v58, v58
  v_exp_f32 v59, v59
  v_exp_f32 v60, v60
  v_exp_f32 v61, v61
  v_mul_f32 v48, v48, v57
  v_mul_f32 v49, v49, v57
  v_mul_f32 v50, v50, v57
  v_mul_f32 v51, v51, v57
  v_cvt_pk_bf16_f32 v62, v58, v59
  v_cvt_pk_bf16_f32 v63, v60, v61
  v_add_f32 v58, v58, v59
  v_add_f32 v60, v60, v61
  v_add_f32 v58, v58, v60
  v_fma_f32 v81, v81, v57, v58
  v_perm_b32 v64, v62, v62, v8
  v_perm_b32 v65, v62, v62, v9
  v_perm_b32 v66, v62, v62, v10
  v_perm_b32 v67, v62, v62, v11
  v_perm_b32 v68, v62, v62, v12
  v_perm_b32 v69, v62, v62, v13
  v_perm_b32 v70, v62, v62, v14
  v_perm_b32 v71, v62, v62, v15
  v_perm_b32 v72, v63, v63, v8
  v_perm_b32 v73, v63, v63, v9
  v_perm_b32 v74, v63, v63, v10
  v_perm_b32 v75, v63, v63, v11
  v_perm_b32 v76, v63, v63, v12
  v_perm_b32 v77, v63, v63, v13
  v_perm_b32 v78, v63, v63, v14
  v_perm_b32 v79, v63, v63, v15
  s_waitcnt vmcnt(28)
  v_mfma_f32_16x16x32_bf16 v[48:51], v[240:243], v[64:67], v[48:51]
  v_mfma_f32_16x16x32_bf16 v[48:51], v[244:247], v[68:71], v[48:51]
  v_mfma_f32_16x16x32_bf16 v[48:51], v[248:251], v[72:75], v[48:51]
  v_mfma_f32_16x16x32_bf16 v[48:51], v[252:255], v[76:79], v[48:51]
  buffer_load_dwordx4 v[240:243], v5, s[24:27], s58 offen offset:0 nt
  buffer_load_dwordx4 v[244:247], v5, s[24:27], s58 offen offset:256 nt
  buffer_load_dwordx4 v[248:251], v5, s[24:27], s58 offen offset:512 nt
  buffer_load_dwordx4 v[252:255], v5, s[24:27], s58 offen offset:768 nt
  s_add_u32 s58, s58, 0x4000
  s_nop 1
  s_setpc_b64 s[62:63]
L_bodyVW:
  s_waitcnt vmcnt(28)
  v_mfma_f32_16x16x32_bf16 v[52:55], v[128:131], v[16:19], 0
  v_mfma_f32_16x16x32_bf16 v[52:55], v[132:135], v[20:23], v[52:55]
  v_mfma_f32_16x16x32_bf16 v[52:55], v[136:139], v[24:27], v[52:55]
  v_mfma_f32_16x16x32_bf16 v[52:55], v[140:143], v[28:31], v[52:55]
  buffer_load_dwordx4 v[128:131], v89, s[20:23], s58 offen offset:0 nt
  buffer_load_dwordx4 v[132:135], v89, s[20:23], s58 offen offset:128 nt
  buffer_load_dwordx4 v[136:139], v89, s[20:23], s58 offen offset:2048 nt
  buffer_load_dwordx4 v[140:143], v89, s[20:23], s58 offen offset:2176 nt
  s_nop 3
  v_max3_f32 v56, v52, v53, v54
  v_max_f32 v56, v56, v55
  v_mov_b32 v57, v56
  s_nop 1
  v_permlane16_swap_b32 v56, v57
  v_max_f32 v56, v56, v57
  v_mov_b32 v57, v56
  s_nop 1
  v_permlane32_swap_b32 v56, v57
  v_max_f32 v56, v56, v57
  v_mul_f32 v56, s59, v56
  v_max_f32 v56, v56, v80
  v_sub_f32 v57, v80, v56
  v_mov_b32 v80, v56
  v_exp_f32 v57, v57
  v_fma_f32 v58, v52, s59, -v56
  v_fma_f32 v59, v53, s59, -v56
  v_fma_f32 v60, v54, s59, -v56
  v_fma_f32 v61, v55, s59, -v56
  v_exp_f32 v58, v58
  v_exp_f32 v59, v59
  v_exp_f32 v60, v60
  v_exp_f32 v61, v61
  v_mul_f32 v48, v48, v57
  v_mul_f32 v49, v49, v57
  v_mul_f32 v50, v50, v57
  v_mul_f32 v51, v51, v57
  v_cvt_pk_bf16_f32 v62, v58, v59
  v_cvt_pk_bf16_f32 v63, v60, v61
  v_add_f32 v58, v58, v59
  v_add_f32 v60, v60, v61
  v_add_f32 v58, v58, v60
  v_fma_f32 v81, v81, v57, v58
  v_perm_b32 v64, v62, v62, v8
  v_perm_b32 v65, v62, v62, v9
  v_perm_b32 v66, v62, v62, v10
  v_perm_b32 v67, v62, v62, v11
  v_perm_b32 v68, v62, v62, v12
  v_perm_b32 v69, v62, v62, v13
  v_perm_b32 v70, v62, v62, v14
  v_perm_b32 v71, v62, v62, v15
  v_perm_b32 v72, v63, v63, v8
  v_perm_b32 v73, v63, v63, v9
  v_perm_b32 v74, v63, v63, v10
  v_perm_b32 v75, v63, v63, v11
  v_perm_b32 v76, v63, v63, v12
  v_perm_b32 v77, v63, v63, v13
  v_perm_b32 v78, v63, v63, v14
  v_perm_b32 v79, v63, v63, v15
  s_waitcnt vmcnt(28)
  v_mfma_f32_16x16x32_bf16 v[48:51], v[144:147], v[64:67], v[48:51]
  v_mfma_f32_16x16x32_bf16 v[48:51], v[148:151], v[68:71], v[48:51]
  v_mfma_f32_16x16x32_bf16 v[48:51], v[152:155], v[72:75], v[48:51]
  v_mfma_f32_16x16x32_bf16 v[48:51], v[156:159], v[76:79], v[48:51]
  buffer_load_dwordx4 v[144:147], v5, s[24:27], s58 offen offset:0 nt
  buffer_load_dwordx4 v[148:151], v5, s[24:27], s58 offen offset:256 nt
  buffer_load_dwordx4 v[152:155], v5, s[24:27], s58 offen offset:512 nt
  buffer_load_dwordx4 v[156:159], v5, s[24:27], s58 offen offset:768 nt
  s_add_u32 s58, s58, 0x4000
  s_waitcnt vmcnt(28)
  v_mfma_f32_16x16x32_bf16 v[52:55], v[160:163], v[16:19], 0
  v_mfma_f32_16x16x32_bf16 v[52:55], v[164:167], v[20:23], v[52:55]
  v_mfma_f32_16x16x32_bf16 v[52:55], v[168:171], v[24:27], v[52:55]
  v_mfma_f32_16x16x32_bf16 v[52:55], v[172:175], v[28:31], v[52:55]
  buffer_load_dwordx4 v[160:163], v89, s[20:23], s58 offen offset:0 nt
  buffer_load_dwordx4 v[164:167], v89, s[20:23], s58 offen offset:128 nt
  buffer_load_dwordx4 v[168:171], v89, s[20:23], s58 offen offset:2048 nt
  buffer_load_dwordx4 v[172:175], v89, s[20:23], s58 offen offset:2176 nt
  s_nop 3
  v_max3_f32 v56, v52, v53, v54
  v_max_f32 v56, v56, v55
  v_mov_b32 v57, v56
  s_nop 1
  v_permlane16_swap_b32 v56, v57
  v_max_f32 v56, v56, v57
  v_mov_b32 v57, v56
  s_nop 1
  v_permlane32_swap_b32 v56, v57
  v_max_f32 v56, v56, v57
  v_mul_f32 v56, s59, v56
  v_max_f32 v56, v56, v80
  v_sub_f32 v57, v80, v56
  v_mov_b32 v80, v56
  v_exp_f32 v57, v57
  v_fma_f32 v58, v52, s59, -v56
  v_fma_f32 v59, v53, s59, -v56
  v_fma_f32 v60, v54, s59, -v56
  v_fma_f32 v61, v55, s59, -v56
  v_exp_f32 v58, v58
  v_exp_f32 v59, v59
  v_exp_f32 v60, v60
  v_exp_f32 v61, v61
  v_mul_f32 v48, v48, v57
  v_mul_f32 v49, v49, v57
  v_mul_f32 v50, v50, v57
  v_mul_f32 v51, v51, v57
  v_cvt_pk_bf16_f32 v62, v58, v59
  v_cvt_pk_bf16_f32 v63, v60, v61
  v_add_f32 v58, v58, v59
  v_add_f32 v60, v60, v61
  v_add_f32 v58, v58, v60
  v_fma_f32 v81, v81, v57, v58
  v_perm_b32 v64, v62, v62, v8
  v_perm_b32 v65, v62, v62, v9
  v_perm_b32 v66, v62, v62, v10
  v_perm_b32 v67, v62, v62, v11
  v_perm_b32 v68, v62, v62, v12
  v_perm_b32 v69, v62, v62, v13
  v_perm_b32 v70, v62, v62, v14
  v_perm_b32 v71, v62, v62, v15
  v_perm_b32 v72, v63, v63, v8
  v_perm_b32 v73, v63, v63, v9
  v_perm_b32 v74, v63, v63, v10
  v_perm_b32 v75, v63, v63, v11
  v_perm_b32 v76, v63, v63, v12
  v_perm_b32 v77, v63, v63, v13
  v_perm_b32 v78, v63, v63, v14
  v_perm_b32 v79, v63, v63, v15
  s_waitcnt vmcnt(28)
  v_mfma_f32_16x16x32_bf16 v[48:51], v[176:179], v[64:67], v[48:51]
  v_mfma_f32_16x16x32_bf16 v[48:51], v[180:183], v[68:71], v[48:51]
  v_mfma_f32_16x16x32_bf16 v[48:51], v[184:187], v[72:75], v[48:51]
  v_mfma_f32_16x16x32_bf16 v[48:51], v[188:191], v[76:79], v[48:51]
  buffer_load_dwordx4 v[176:179], v5, s[24:27], s58 offen offset:0 nt
  buffer_load_dwordx4 v[180:183], v5, s[24:27], s58 offen offset:256 nt
  buffer_load_dwordx4 v[184:187], v5, s[24:27], s58 offen offset:512 nt
  buffer_load_dwordx4 v[188:191], v5, s[24:27], s58 offen offset:768 nt
  s_add_u32 s58, s58, 0x4000
  s_waitcnt vmcnt(28)
  v_mfma_f32_16x16x32_bf16 v[52:55], v[192:195], v[16:19], 0
  v_mfma_f32_16x16x32_bf16 v[52:55], v[196:199], v[20:23], v[52:55]
  v_mfma_f32_16x16x32_bf16 v[52:55], v[200:203], v[24:27], v[52:55]
  v_mfma_f32_16x16x32_bf16 v[52:55], v[204:207], v[28:31], v[52:55]
  buffer_load_dwordx4 v[192:195], v89, s[20:23], s58 offen offset:0 nt
  buffer_load_dwordx4 v[196:199], v89, s[20:23], s58 offen offset:128 nt
  buffer_load_dwordx4 v[200:203], v89, s[20:23], s58 offen offset:2048 nt
  buffer_load_dwordx4 v[204:207], v89, s[20:23], s58 offen offset:2176 nt
  s_nop 3
  v_max3_f32 v56, v52, v53, v54
  v_max_f32 v56, v56, v55
  v_mov_b32 v57, v56
  s_nop 1
  v_permlane16_swap_b32 v56, v57
  v_max_f32 v56, v56, v57
  v_mov_b32 v57, v56
  s_nop 1
  v_permlane32_swap_b32 v56, v57
  v_max_f32 v56, v56, v57
  v_mul_f32 v56, s59, v56
  v_max_f32 v56, v56, v80
  v_sub_f32 v57, v80, v56
  v_mov_b32 v80, v56
  v_exp_f32 v57, v57
  v_fma_f32 v58, v52, s59, -v56
  v_fma_f32 v59, v53, s59, -v56
  v_fma_f32 v60, v54, s59, -v56
  v_fma_f32 v61, v55, s59, -v56
  v_exp_f32 v58, v58
  v_exp_f32 v59, v59
  v_exp_f32 v60, v60
  v_exp_f32 v61, v61
  v_mul_f32 v48, v48, v57
  v_mul_f32 v49, v49, v57
  v_mul_f32 v50, v50, v57
  v_mul_f32 v51, v51, v57
  v_cvt_pk_bf16_f32 v62, v58, v59
  v_cvt_pk_bf16_f32 v63, v60, v61
  v_add_f32 v58, v58, v59
  v_add_f32 v60, v60, v61
  v_add_f32 v58, v58, v60
  v_fma_f32 v81, v81, v57, v58
  v_perm_b32 v64, v62, v62, v8
  v_perm_b32 v65, v62, v62, v9
  v_perm_b32 v66, v62, v62, v10
  v_perm_b32 v67, v62, v62, v11
  v_perm_b32 v68, v62, v62, v12
  v_perm_b32 v69, v62, v62, v13
  v_perm_b32 v70, v62, v62, v14
  v_perm_b32 v71, v62, v62, v15
  v_perm_b32 v72, v63, v63, v8
  v_perm_b32 v73, v63, v63, v9
  v_perm_b32 v74, v63, v63, v10
  v_perm_b32 v75, v63, v63, v11
  v_perm_b32 v76, v63, v63, v12
  v_perm_b32 v77, v63, v63, v13
  v_perm_b32 v78, v63, v63, v14
  v_perm_b32 v79, v63, v63, v15
  s_waitcnt vmcnt(28)
  v_mfma_f32_16x16x32_bf16 v[48:51], v[208:211], v[64:67], v[48:51]
  v_mfma_f32_16x16x32_bf16 v[48:51], v[212:215], v[68:71], v[48:51]
  v_mfma_f32_16x16x32_bf16 v[48:51], v[216:219], v[72:75], v[48:51]
  v_mfma_f32_16x16x32_bf16 v[48:51], v[220:223], v[76:79], v[48:51]
  buffer_load_dwordx4 v[208:211], v5, s[24:27], s58 offen offset:0 nt
  buffer_load_dwordx4 v[212:215], v5, s[24:27], s58 offen offset:256 nt
  buffer_load_dwordx4 v[216:219], v5, s[24:27], s58 offen offset:512 nt
  buffer_load_dwordx4 v[220:223], v5, s[24:27], s58 offen offset:768 nt
  s_add_u32 s58, s58, 0x4000
  s_waitcnt vmcnt(28)
  v_mfma_f32_16x16x32_bf16 v[52:55], v[224:227], v[16:19], 0
  v_mfma_f32_16x16x32_bf16 v[52:55], v[228:231], v[20:23], v[52:55]
  v_mfma_f32_16x16x32_bf16 v[52:55], v[232:235], v[24:27], v[52:55]
  v_mfma_f32_16x16x32_bf16 v[52:55], v[236:239], v[28:31], v[52:55]
  buffer_load_dwordx4 v[224:227], v89, s[20:23], s58 offen offset:0 nt
  buffer_load_dwordx4 v[228:231], v89, s[20:23], s58 offen offset:128 nt
  buffer_load_dwordx4 v[232:235], v89, s[20:23], s58 offen offset:2048 nt
  buffer_load_dwordx4 v[236:239], v89, s[20:23], s58 offen offset:2176 nt
  s_nop 3
  v_max3_f32 v56, v52, v53, v54
  v_max_f32 v56, v56, v55
  v_mov_b32 v57, v56
  s_nop 1
  v_permlane16_swap_b32 v56, v57
  v_max_f32 v56, v56, v57
  v_mov_b32 v57, v56
  s_nop 1
  v_permlane32_swap_b32 v56, v57
  v_max_f32 v56, v56, v57
  v_mul_f32 v56, s59, v56
  v_max_f32 v56, v56, v80
  v_sub_f32 v57, v80, v56
  v_mov_b32 v80, v56
  v_exp_f32 v57, v57
  v_fma_f32 v58, v52, s59, -v56
  v_fma_f32 v59, v53, s59, -v56
  v_fma_f32 v60, v54, s59, -v56
  v_fma_f32 v61, v55, s59, -v56
  v_exp_f32 v58, v58
  v_exp_f32 v59, v59
  v_exp_f32 v60, v60
  v_exp_f32 v61, v61
  v_mul_f32 v48, v48, v57
  v_mul_f32 v49, v49, v57
  v_mul_f32 v50, v50, v57
  v_mul_f32 v51, v51, v57
  v_cvt_pk_bf16_f32 v62, v58, v59
  v_cvt_pk_bf16_f32 v63, v60, v61
  v_add_f32 v58, v58, v59
  v_add_f32 v60, v60, v61
  v_add_f32 v58, v58, v60
  v_fma_f32 v81, v81, v57, v58
  v_perm_b32 v64, v62, v62, v8
  v_perm_b32 v65, v62, v62, v9
  v_perm_b32 v66, v62, v62, v10
  v_perm_b32 v67, v62, v62, v11
  v_perm_b32 v68, v62, v62, v12
  v_perm_b32 v69, v62, v62, v13
  v_perm_b32 v70, v62, v62, v14
  v_perm_b32 v71, v62, v62, v15
  v_perm_b32 v72, v63, v63, v8
  v_perm_b32 v73, v63, v63, v9
  v_perm_b32 v74, v63, v63, v10
  v_perm_b32 v75, v63, v63, v11
  v_perm_b32 v76, v63, v63, v12
  v_perm_b32 v77, v63, v63, v13
  v_perm_b32 v78, v63, v63, v14
  v_perm_b32 v79, v63, v63, v15
  s_waitcnt vmcnt(28)
  v_mfma_f32_16x16x32_bf16 v[48:51], v[240:243], v[64:67], v[48:51]
  v_mfma_f32_16x16x32_bf16 v[48:51], v[244:247], v[68:71], v[48:51]
  v_mfma_f32_16x16x32_bf16 v[48:51], v[248:251], v[72:75], v[48:51]
  v_mfma_f32_16x16x32_bf16 v[48:51], v[252:255], v[76:79], v[48:51]
  buffer_load_dwordx4 v[240:243], v5, s[24:27], s58 offen offset:0 nt
  buffer_load_dwordx4 v[244:247], v5, s[24:27], s58 offen offset:256 nt
  buffer_load_dwordx4 v[248:251], v5, s[24:27], s58 offen offset:512 nt
  buffer_load_dwordx4 v[252:255], v5, s[24:27], s58 offen offset:768 nt
  s_add_u32 s58, s58, 0x4000
  s_nop 1
  s_setpc_b64 s[62:63]
L_bodyWW:
  s_waitcnt vmcnt(28)
  v_mfma_f32_16x16x32_bf16 v[52:55], v[128:131], v[32:35], 0
  v_mfma_f32_16x16x32_bf16 v[58:61], v[136:139], v[32:35], 0
  v_mfma_f32_16x16x32_bf16 v[52:55], v[132:135], v[36:39], v[52:55]
  v_mfma_f32_16x16x32_bf16 v[58:61], v[140:143], v[36:39], v[58:61]
  buffer_load_dwordx4 v[128:131], v89, s[20:23], s58 offen offset:0 nt
  buffer_load_dwordx4 v[132:135], v89, s[20:23], s58 offen offset:128 nt
  buffer_load_dwordx4 v[136:139], v89, s[20:23], s58 offen offset:2048 nt
  buffer_load_dwordx4 v[140:143], v89, s[20:23], s58 offen offset:2176 nt
  s_nop 3
  v_permlane32_swap_b32 v52, v58
  v_permlane32_swap_b32 v53, v59
  v_permlane32_swap_b32 v54, v60
  v_permlane32_swap_b32 v55, v61
  v_mov_b32_dpp v58, v58 quad_perm:[1,1,3,3] row_mask:0xf bank_mask:0xf
  v_mov_b32_dpp v59, v59 quad_perm:[1,1,3,3] row_mask:0xf bank_mask:0xf
  v_mov_b32_dpp v60, v60 quad_perm:[1,1,3,3] row_mask:0xf bank_mask:0xf
  v_mov_b32_dpp v61, v61 quad_perm:[1,1,3,3] row_mask:0xf bank_mask:0xf
  v_add_f32_dpp v52, v52, v58 quad_perm:[0,0,2,2] row_mask:0xf bank_mask:0xf
  v_add_f32_dpp v53, v53, v59 quad_perm:[0,0,2,2] row_mask:0xf bank_mask:0xf
  v_add_f32_dpp v54, v54, v60 quad_perm:[0,0,2,2] row_mask:0xf bank_mask:0xf
  v_add_f32_dpp v55, v55, v61 quad_perm:[0,0,2,2] row_mask:0xf bank_mask:0xf
  v_max3_f32 v56, v52, v53, v54
  v_max_f32 v56, v56, v55
  v_mov_b32 v57, v56
  s_nop 1
  v_permlane16_swap_b32 v56, v57
  v_max_f32 v56, v56, v57
  v_mov_b32 v57, v56
  s_nop 1
  v_permlane32_swap_b32 v56, v57
  v_max_f32 v56, v56, v57
  v_mul_f32 v56, s59, v56
  v_max_f32 v56, v56, v80
  v_sub_f32 v57, v80, v56
  v_mov_b32 v80, v56
  v_exp_f32 v57, v57
  v_fma_f32 v58, v52, s59, -v56
  v_fma_f32 v59, v53, s59, -v56
  v_fma_f32 v60, v54, s59, -v56
  v_fma_f32 v61, v55, s59, -v56
  v_exp_f32 v58, v58
  v_exp_f32 v59, v59
  v_exp_f32 v60, v60
  v_exp_f32 v61, v61
  v_mul_f32 v48, v48, v57
  v_mul_f32 v49, v49, v57
  v_mul_f32 v50, v50, v57
  v_mul_f32 v51, v51, v57
  v_cvt_pk_bf16_f32 v62, v58, v59
  v_cvt_pk_bf16_f32 v63, v60, v61
  v_add_f32 v58, v58, v59
  v_add_f32 v60, v60, v61
  v_add_f32 v58, v58, v60
  v_fma_f32 v81, v81, v57, v58
  v_perm_b32 v64, v62, v62, v8
  v_perm_b32 v65, v62, v62, v9
  v_perm_b32 v66, v62, v62, v10
  v_perm_b32 v67, v62, v62, v11
  v_perm_b32 v68, v62, v62, v12
  v_perm_b32 v69, v62, v62, v13
  v_perm_b32 v70, v62, v62, v14
  v_perm_b32 v71, v62, v62, v15
  v_perm_b32 v72, v63, v63, v8
  v_perm_b32 v73, v63, v63, v9
  v_perm_b32 v74, v63, v63, v10
  v_perm_b32 v75, v63, v63, v11
  v_perm_b32 v76, v63, v63, v12
  v_perm_b32 v77, v63, v63, v13
  v_perm_b32 v78, v63, v63, v14
  v_perm_b32 v79, v63, v63, v15
  s_waitcnt vmcnt(28)
  v_mfma_f32_16x16x32_bf16 v[48:51], v[144:147], v[64:67], v[48:51]
  v_mfma_f32_16x16x32_bf16 v[48:51], v[148:151], v[68:71], v[48:51]
  v_mfma_f32_16x16x32_bf16 v[48:51], v[152:155], v[72:75], v[48:51]
  v_mfma_f32_16x16x32_bf16 v[48:51], v[156:159], v[76:79], v[48:51]
  buffer_load_dwordx4 v[144:147], v5, s[24:27], s58 offen offset:0 nt
  buffer_load_dwordx4 v[148:151], v5, s[24:27], s58 offen offset:256 nt
  buffer_load_dwordx4 v[152:155], v5, s[24:27], s58 offen offset:512 nt
  buffer_load_dwordx4 v[156:159], v5, s[24:27], s58 offen offset:768 nt
  s_add_u32 s58, s58, 0x4000
  s_waitcnt vmcnt(28)
  v_mfma_f32_16x16x32_bf16 v[52:55], v[160:163], v[32:35], 0
  v_mfma_f32_16x16x32_bf16 v[58:61], v[168:171], v[32:35], 0
  v_mfma_f32_16x16x32_bf16 v[52:55], v[164:167], v[36:39], v[52:55]
  v_mfma_f32_16x16x32_bf16 v[58:61], v[172:175], v[36:39], v[58:61]
  buffer_load_dwordx4 v[160:163], v89, s[20:23], s58 offen offset:0 nt
  buffer_load_dwordx4 v[164:167], v89, s[20:23], s58 offen offset:128 nt
  buffer_load_dwordx4 v[168:171], v89, s[20:23], s58 offen offset:2048 nt
  buffer_load_dwordx4 v[172:175], v89, s[20:23], s58 offen offset:2176 nt
  s_nop 3
  v_permlane32_swap_b32 v52, v58
  v_permlane32_swap_b32 v53, v59
  v_permlane32_swap_b32 v54, v60
  v_permlane32_swap_b32 v55, v61
  v_mov_b32_dpp v58, v58 quad_perm:[1,1,3,3] row_mask:0xf bank_mask:0xf
  v_mov_b32_dpp v59, v59 quad_perm:[1,1,3,3] row_mask:0xf bank_mask:0xf
  v_mov_b32_dpp v60, v60 quad_perm:[1,1,3,3] row_mask:0xf bank_mask:0xf
  v_mov_b32_dpp v61, v61 quad_perm:[1,1,3,3] row_mask:0xf bank_mask:0xf
  v_add_f32_dpp v52, v52, v58 quad_perm:[0,0,2,2] row_mask:0xf bank_mask:0xf
  v_add_f32_dpp v53, v53, v59 quad_perm:[0,0,2,2] row_mask:0xf bank_mask:0xf
  v_add_f32_dpp v54, v54, v60 quad_perm:[0,0,2,2] row_mask:0xf bank_mask:0xf
  v_add_f32_dpp v55, v55, v61 quad_perm:[0,0,2,2] row_mask:0xf bank_mask:0xf
  v_max3_f32 v56, v52, v53, v54
  v_max_f32 v56, v56, v55
  v_mov_b32 v57, v56
  s_nop 1
  v_permlane16_swap_b32 v56, v57
  v_max_f32 v56, v56, v57
  v_mov_b32 v57, v56
  s_nop 1
  v_permlane32_swap_b32 v56, v57
  v_max_f32 v56, v56, v57
  v_mul_f32 v56, s59, v56
  v_max_f32 v56, v56, v80
  v_sub_f32 v57, v80, v56
  v_mov_b32 v80, v56
  v_exp_f32 v57, v57
  v_fma_f32 v58, v52, s59, -v56
  v_fma_f32 v59, v53, s59, -v56
  v_fma_f32 v60, v54, s59, -v56
  v_fma_f32 v61, v55, s59, -v56
  v_exp_f32 v58, v58
  v_exp_f32 v59, v59
  v_exp_f32 v60, v60
  v_exp_f32 v61, v61
  v_mul_f32 v48, v48, v57
  v_mul_f32 v49, v49, v57
  v_mul_f32 v50, v50, v57
  v_mul_f32 v51, v51, v57
  v_cvt_pk_bf16_f32 v62, v58, v59
  v_cvt_pk_bf16_f32 v63, v60, v61
  v_add_f32 v58, v58, v59
  v_add_f32 v60, v60, v61
  v_add_f32 v58, v58, v60
  v_fma_f32 v81, v81, v57, v58
  v_perm_b32 v64, v62, v62, v8
  v_perm_b32 v65, v62, v62, v9
  v_perm_b32 v66, v62, v62, v10
  v_perm_b32 v67, v62, v62, v11
  v_perm_b32 v68, v62, v62, v12
  v_perm_b32 v69, v62, v62, v13
  v_perm_b32 v70, v62, v62, v14
  v_perm_b32 v71, v62, v62, v15
  v_perm_b32 v72, v63, v63, v8
  v_perm_b32 v73, v63, v63, v9
  v_perm_b32 v74, v63, v63, v10
  v_perm_b32 v75, v63, v63, v11
  v_perm_b32 v76, v63, v63, v12
  v_perm_b32 v77, v63, v63, v13
  v_perm_b32 v78, v63, v63, v14
  v_perm_b32 v79, v63, v63, v15
  s_waitcnt vmcnt(28)
  v_mfma_f32_16x16x32_bf16 v[48:51], v[176:179], v[64:67], v[48:51]
  v_mfma_f32_16x16x32_bf16 v[48:51], v[180:183], v[68:71], v[48:51]
  v_mfma_f32_16x16x32_bf16 v[48:51], v[184:187], v[72:75], v[48:51]
  v_mfma_f32_16x16x32_bf16 v[48:51], v[188:191], v[76:79], v[48:51]
  buffer_load_dwordx4 v[176:179], v5, s[24:27], s58 offen offset:0 nt
  buffer_load_dwordx4 v[180:183], v5, s[24:27], s58 offen offset:256 nt
  buffer_load_dwordx4 v[184:187], v5, s[24:27], s58 offen offset:512 nt
  buffer_load_dwordx4 v[188:191], v5, s[24:27], s58 offen offset:768 nt
  s_add_u32 s58, s58, 0x4000
  s_waitcnt vmcnt(28)
  v_mfma_f32_16x16x32_bf16 v[52:55], v[192:195], v[32:35], 0
  v_mfma_f32_16x16x32_bf16 v[58:61], v[200:203], v[32:35], 0
  v_mfma_f32_16x16x32_bf16 v[52:55], v[196:199], v[36:39], v[52:55]
  v_mfma_f32_16x16x32_bf16 v[58:61], v[204:207], v[36:39], v[58:61]
  buffer_load_dwordx4 v[192:195], v89, s[20:23], s58 offen offset:0 nt
  buffer_load_dwordx4 v[196:199], v89, s[20:23], s58 offen offset:128 nt
  buffer_load_dwordx4 v[200:203], v89, s[20:23], s58 offen offset:2048 nt
  buffer_load_dwordx4 v[204:207], v89, s[20:23], s58 offen offset:2176 nt
  s_nop 3
  v_permlane32_swap_b32 v52, v58
  v_permlane32_swap_b32 v53, v59
  v_permlane32_swap_b32 v54, v60
  v_permlane32_swap_b32 v55, v61
  v_mov_b32_dpp v58, v58 quad_perm:[1,1,3,3] row_mask:0xf bank_mask:0xf
  v_mov_b32_dpp v59, v59 quad_perm:[1,1,3,3] row_mask:0xf bank_mask:0xf
  v_mov_b32_dpp v60, v60 quad_perm:[1,1,3,3] row_mask:0xf bank_mask:0xf
  v_mov_b32_dpp v61, v61 quad_perm:[1,1,3,3] row_mask:0xf bank_mask:0xf
  v_add_f32_dpp v52, v52, v58 quad_perm:[0,0,2,2] row_mask:0xf bank_mask:0xf
  v_add_f32_dpp v53, v53, v59 quad_perm:[0,0,2,2] row_mask:0xf bank_mask:0xf
  v_add_f32_dpp v54, v54, v60 quad_perm:[0,0,2,2] row_mask:0xf bank_mask:0xf
  v_add_f32_dpp v55, v55, v61 quad_perm:[0,0,2,2] row_mask:0xf bank_mask:0xf
  v_max3_f32 v56, v52, v53, v54
  v_max_f32 v56, v56, v55
  v_mov_b32 v57, v56
  s_nop 1
  v_permlane16_swap_b32 v56, v57
  v_max_f32 v56, v56, v57
  v_mov_b32 v57, v56
  s_nop 1
  v_permlane32_swap_b32 v56, v57
  v_max_f32 v56, v56, v57
  v_mul_f32 v56, s59, v56
  v_max_f32 v56, v56, v80
  v_sub_f32 v57, v80, v56
  v_mov_b32 v80, v56
  v_exp_f32 v57, v57
  v_fma_f32 v58, v52, s59, -v56
  v_fma_f32 v59, v53, s59, -v56
  v_fma_f32 v60, v54, s59, -v56
  v_fma_f32 v61, v55, s59, -v56
  v_exp_f32 v58, v58
  v_exp_f32 v59, v59
  v_exp_f32 v60, v60
  v_exp_f32 v61, v61
  v_mul_f32 v48, v48, v57
  v_mul_f32 v49, v49, v57
  v_mul_f32 v50, v50, v57
  v_mul_f32 v51, v51, v57
  v_cvt_pk_bf16_f32 v62, v58, v59
  v_cvt_pk_bf16_f32 v63, v60, v61
  v_add_f32 v58, v58, v59
  v_add_f32 v60, v60, v61
  v_add_f32 v58, v58, v60
  v_fma_f32 v81, v81, v57, v58
  v_perm_b32 v64, v62, v62, v8
  v_perm_b32 v65, v62, v62, v9
  v_perm_b32 v66, v62, v62, v10
  v_perm_b32 v67, v62, v62, v11
  v_perm_b32 v68, v62, v62, v12
  v_perm_b32 v69, v62, v62, v13
  v_perm_b32 v70, v62, v62, v14
  v_perm_b32 v71, v62, v62, v15
  v_perm_b32 v72, v63, v63, v8
  v_perm_b32 v73, v63, v63, v9
  v_perm_b32 v74, v63, v63, v10
  v_perm_b32 v75, v63, v63, v11
  v_perm_b32 v76, v63, v63, v12
  v_perm_b32 v77, v63, v63, v13
  v_perm_b32 v78, v63, v63, v14
  v_perm_b32 v79, v63, v63, v15
  s_waitcnt vmcnt(28)
  v_mfma_f32_16x16x32_bf16 v[48:51], v[208:211], v[64:67], v[48:51]
  v_mfma_f32_16x16x32_bf16 v[48:51], v[212:215], v[68:71], v[48:51]
  v_mfma_f32_16x16x32_bf16 v[48:51], v[216:219], v[72:75], v[48:51]
  v_mfma_f32_16x16x32_bf16 v[48:51], v[220:223], v[76:79], v[48:51]
  buffer_load_dwordx4 v[208:211], v5, s[24:27], s58 offen offset:0 nt
  buffer_load_dwordx4 v[212:215], v5, s[24:27], s58 offen offset:256 nt
  buffer_load_dwordx4 v[216:219], v5, s[24:27], s58 offen offset:512 nt
  buffer_load_dwordx4 v[220:223], v5, s[24:27], s58 offen offset:768 nt
  s_add_u32 s58, s58, 0x4000
  s_waitcnt vmcnt(28)
  v_mfma_f32_16x16x32_bf16 v[52:55], v[224:227], v[32:35], 0
  v_mfma_f32_16x16x32_bf16 v[58:61], v[232:235], v[32:35], 0
  v_mfma_f32_16x16x32_bf16 v[52:55], v[228:231], v[36:39], v[52:55]
  v_mfma_f32_16x16x32_bf16 v[58:61], v[236:239], v[36:39], v[58:61]
  buffer_load_dwordx4 v[224:227], v89, s[20:23], s58 offen offset:0 nt
  buffer_load_dwordx4 v[228:231], v89, s[20:23], s58 offen offset:128 nt
  buffer_load_dwordx4 v[232:235], v89, s[20:23], s58 offen offset:2048 nt
  buffer_load_dwordx4 v[236:239], v89, s[20:23], s58 offen offset:2176 nt
  s_nop 3
  v_permlane32_swap_b32 v52, v58
  v_permlane32_swap_b32 v53, v59
  v_permlane32_swap_b32 v54, v60
  v_permlane32_swap_b32 v55, v61
  v_mov_b32_dpp v58, v58 quad_perm:[1,1,3,3] row_mask:0xf bank_mask:0xf
  v_mov_b32_dpp v59, v59 quad_perm:[1,1,3,3] row_mask:0xf bank_mask:0xf
  v_mov_b32_dpp v60, v60 quad_perm:[1,1,3,3] row_mask:0xf bank_mask:0xf
  v_mov_b32_dpp v61, v61 quad_perm:[1,1,3,3] row_mask:0xf bank_mask:0xf
  v_add_f32_dpp v52, v52, v58 quad_perm:[0,0,2,2] row_mask:0xf bank_mask:0xf
  v_add_f32_dpp v53, v53, v59 quad_perm:[0,0,2,2] row_mask:0xf bank_mask:0xf
  v_add_f32_dpp v54, v54, v60 quad_perm:[0,0,2,2] row_mask:0xf bank_mask:0xf
  v_add_f32_dpp v55, v55, v61 quad_perm:[0,0,2,2] row_mask:0xf bank_mask:0xf
  v_max3_f32 v56, v52, v53, v54
  v_max_f32 v56, v56, v55
  v_mov_b32 v57, v56
  s_nop 1
  v_permlane16_swap_b32 v56, v57
  v_max_f32 v56, v56, v57
  v_mov_b32 v57, v56
  s_nop 1
  v_permlane32_swap_b32 v56, v57
  v_max_f32 v56, v56, v57
  v_mul_f32 v56, s59, v56
  v_max_f32 v56, v56, v80
  v_sub_f32 v57, v80, v56
  v_mov_b32 v80, v56
  v_exp_f32 v57, v57
  v_fma_f32 v58, v52, s59, -v56
  v_fma_f32 v59, v53, s59, -v56
  v_fma_f32 v60, v54, s59, -v56
  v_fma_f32 v61, v55, s59, -v56
  v_exp_f32 v58, v58
  v_exp_f32 v59, v59
  v_exp_f32 v60, v60
  v_exp_f32 v61, v61
  v_mul_f32 v48, v48, v57
  v_mul_f32 v49, v49, v57
  v_mul_f32 v50, v50, v57
  v_mul_f32 v51, v51, v57
  v_cvt_pk_bf16_f32 v62, v58, v59
  v_cvt_pk_bf16_f32 v63, v60, v61
  v_add_f32 v58, v58, v59
  v_add_f32 v60, v60, v61
  v_add_f32 v58, v58, v60
  v_fma_f32 v81, v81, v57, v58
  v_perm_b32 v64, v62, v62, v8
  v_perm_b32 v65, v62, v62, v9
  v_perm_b32 v66, v62, v62, v10
  v_perm_b32 v67, v62, v62, v11
  v_perm_b32 v68, v62, v62, v12
  v_perm_b32 v69, v62, v62, v13
  v_perm_b32 v70, v62, v62, v14
  v_perm_b32 v71, v62, v62, v15
  v_perm_b32 v72, v63, v63, v8
  v_perm_b32 v73, v63, v63, v9
  v_perm_b32 v74, v63, v63, v10
  v_perm_b32 v75, v63, v63, v11
  v_perm_b32 v76, v63, v63, v12
  v_perm_b32 v77, v63, v63, v13
  v_perm_b32 v78, v63, v63, v14
  v_perm_b32 v79, v63, v63, v15
  s_waitcnt vmcnt(28)
  v_mfma_f32_16x16x32_bf16 v[48:51], v[240:243], v[64:67], v[48:51]
  v_mfma_f32_16x16x32_bf16 v[48:51], v[244:247], v[68:71], v[48:51]
  v_mfma_f32_16x16x32_bf16 v[48:51], v[248:251], v[72:75], v[48:51]
  v_mfma_f32_16x16x32_bf16 v[48:51], v[252:255], v[76:79], v[48:51]
  buffer_load_dwordx4 v[240:243], v5, s[24:27], s58 offen offset:0 nt
  buffer_load_dwordx4 v[244:247], v5, s[24:27], s58 offen offset:256 nt
  buffer_load_dwordx4 v[248:251], v5, s[24:27], s58 offen offset:512 nt
  buffer_load_dwordx4 v[252:255], v5, s[24:27], s58 offen offset:768 nt
  s_add_u32 s58, s58, 0x4000
  s_nop 1
  s_setpc_b64 s[62:63]
L_bodyW:
  s_waitcnt vmcnt(28)
  v_mfma_f32_16x16x32_bf16 v[52:55], v[128:131], v[32:35], 0
  v_mfma_f32_16x16x32_bf16 v[58:61], v[136:139], v[32:35], 0
  v_mfma_f32_16x16x32_bf16 v[52:55], v[132:135], v[36:39], v[52:55]
  v_mfma_f32_16x16x32_bf16 v[58:61], v[140:143], v[36:39], v[58:61]
  s_nop 7
  v_permlane32_swap_b32 v52, v58
  v_permlane32_swap_b32 v53, v59
  v_permlane32_swap_b32 v54, v60
  v_permlane32_swap_b32 v55, v61
  v_mov_b32_dpp v58, v58 quad_perm:[1,1,3,3] row_mask:0xf bank_mask:0xf
  v_mov_b32_dpp v59, v59 quad_perm:[1,1,3,3] row_mask:0xf bank_mask:0xf
  v_mov_b32_dpp v60, v60 quad_perm:[1,1,3,3] row_mask:0xf bank_mask:0xf
  v_mov_b32_dpp v61, v61 quad_perm:[1,1,3,3] row_mask:0xf bank_mask:0xf
  v_add_f32_dpp v52, v52, v58 quad_perm:[0,0,2,2] row_mask:0xf bank_mask:0xf
  v_add_f32_dpp v53, v53, v59 quad_perm:[0,0,2,2] row_mask:0xf bank_mask:0xf
  v_add_f32_dpp v54, v54, v60 quad_perm:[0,0,2,2] row_mask:0xf bank_mask:0xf
  v_add_f32_dpp v55, v55, v61 quad_perm:[0,0,2,2] row_mask:0xf bank_mask:0xf
  v_max3_f32 v56, v52, v53, v54
  v_max_f32 v56, v56, v55
  v_mov_b32 v57, v56
  s_nop 1
  v_permlane16_swap_b32 v56, v57
  v_max_f32 v56, v56, v57
  v_mov_b32 v57, v56
  s_nop 1
  v_permlane32_swap_b32 v56, v57
  v_max_f32 v56, v56, v57
  v_mul_f32 v56, s59, v56
  v_max_f32 v56, v56, v80
  v_sub_f32 v57, v80, v56
  v_mov_b32 v80, v56
  v_exp_f32 v57, v57
  v_fma_f32 v58, v52, s59, -v56
  v_fma_f32 v59, v53, s59, -v56
  v_fma_f32 v60, v54, s59, -v56
  v_fma_f32 v61, v55, s59, -v56
  v_exp_f32 v58, v58
  v_exp_f32 v59, v59
  v_exp_f32 v60, v60
  v_exp_f32 v61, v61
  v_mul_f32 v48, v48, v57
  v_mul_f32 v49, v49, v57
  v_mul_f32 v50, v50, v57
  v_mul_f32 v51, v51, v57
  v_cvt_pk_bf16_f32 v62, v58, v59
  v_cvt_pk_bf16_f32 v63, v60, v61
  v_add_f32 v58, v58, v59
  v_add_f32 v60, v60, v61
  v_add_f32 v58, v58, v60
  v_fma_f32 v81, v81, v57, v58
  v_perm_b32 v64, v62, v62, v8
  v_perm_b32 v65, v62, v62, v9
  v_perm_b32 v66, v62, v62, v10
  v_perm_b32 v67, v62, v62, v11
  v_perm_b32 v68, v62, v62, v12
  v_perm_b32 v69, v62, v62, v13
  v_perm_b32 v70, v62, v62, v14
  v_perm_b32 v71, v62, v62, v15
  v_perm_b32 v72, v63, v63, v8
  v_perm_b32 v73, v63, v63, v9
  v_perm_b32 v74, v63, v63, v10
  v_perm_b32 v75, v63, v63, v11
  v_perm_b32 v76, v63, v63, v12
  v_perm_b32 v77, v63, v63, v13
  v_perm_b32 v78, v63, v63, v14
  v_perm_b32 v79, v63, v63, v15
  s_waitcnt vmcnt(24)
  v_mfma_f32_16x16x32_bf16 v[48:51], v[144:147], v[64:67], v[48:51]
  v_mfma_f32_16x16x32_bf16 v[48:51], v[148:151], v[68:71], v[48:51]
  v_mfma_f32_16x16x32_bf16 v[48:51], v[152:155], v[72:75], v[48:51]
  v_mfma_f32_16x16x32_bf16 v[48:51], v[156:159], v[76:79], v[48:51]
  s_waitcnt vmcnt(20)
  v_mfma_f32_16x16x32_bf16 v[52:55], v[160:163], v[32:35], 0
  v_mfma_f32_16x16x32_bf16 v[58:61], v[168:171], v[32:35], 0
  v_mfma_f32_16x16x32_bf16 v[52:55], v[164:167], v[36:39], v[52:55]
  v_mfma_f32_16x16x32_bf16 v[58:61], v[172:175], v[36:39], v[58:61]
  s_nop 7
  v_permlane32_swap_b32 v52, v58
  v_permlane32_swap_b32 v53, v59
  v_permlane32_swap_b32 v54, v60
  v_permlane32_swap_b32 v55, v61
  v_mov_b32_dpp v58, v58 quad_perm:[1,1,3,3] row_mask:0xf bank_mask:0xf
  v_mov_b32_dpp v59, v59 quad_perm:[1,1,3,3] row_mask:0xf bank_mask:0xf
  v_mov_b32_dpp v60, v60 quad_perm:[1,1,3,3] row_mask:0xf bank_mask:0xf
  v_mov_b32_dpp v61, v61 quad_perm:[1,1,3,3] row_mask:0xf bank_mask:0xf
  v_add_f32_dpp v52, v52, v58 quad_perm:[0,0,2,2] row_mask:0xf bank_mask:0xf
  v_add_f32_dpp v53, v53, v59 quad_perm:[0,0,2,2] row_mask:0xf bank_mask:0xf
  v_add_f32_dpp v54, v54, v60 quad_perm:[0,0,2,2] row_mask:0xf bank_mask:0xf
  v_add_f32_dpp v55, v55, v61 quad_perm:[0,0,2,2] row_mask:0xf bank_mask:0xf
  v_max3_f32 v56, v52, v53, v54
  v_max_f32 v56, v56, v55
  v_mov_b32 v57, v56
  s_nop 1
  v_permlane16_swap_b32 v56, v57
  v_max_f32 v56, v56, v57
  v_mov_b32 v57, v56
  s_nop 1
  v_permlane32_swap_b32 v56, v57
  v_max_f32 v56, v56, v57
  v_mul_f32 v56, s59, v56
  v_max_f32 v56, v56, v80
  v_sub_f32 v57, v80, v56
  v_mov_b32 v80, v56
  v_exp_f32 v57, v57
  v_fma_f32 v58, v52, s59, -v56
  v_fma_f32 v59, v53, s59, -v56
  v_fma_f32 v60, v54, s59, -v56
  v_fma_f32 v61, v55, s59, -v56
  v_exp_f32 v58, v58
  v_exp_f32 v59, v59
  v_exp_f32 v60, v60
  v_exp_f32 v61, v61
  v_mul_f32 v48, v48, v57
  v_mul_f32 v49, v49, v57
  v_mul_f32 v50, v50, v57
  v_mul_f32 v51, v51, v57
  v_cvt_pk_bf16_f32 v62, v58, v59
  v_cvt_pk_bf16_f32 v63, v60, v61
  v_add_f32 v58, v58, v59
  v_add_f32 v60, v60, v61
  v_add_f32 v58, v58, v60
  v_fma_f32 v81, v81, v57, v58
  v_perm_b32 v64, v62, v62, v8
  v_perm_b32 v65, v62, v62, v9
  v_perm_b32 v66, v62, v62, v10
  v_perm_b32 v67, v62, v62, v11
  v_perm_b32 v68, v62, v62, v12
  v_perm_b32 v69, v62, v62, v13
  v_perm_b32 v70, v62, v62, v14
  v_perm_b32 v71, v62, v62, v15
  v_perm_b32 v72, v63, v63, v8
  v_perm_b32 v73, v63, v63, v9
  v_perm_b32 v74, v63, v63, v10
  v_perm_b32 v75, v63, v63, v11
  v_perm_b32 v76, v63, v63, v12
  v_perm_b32 v77, v63, v63, v13
  v_perm_b32 v78, v63, v63, v14
  v_perm_b32 v79, v63, v63, v15
  s_waitcnt vmcnt(16)
  v_mfma_f32_16x16x32_bf16 v[48:51], v[176:179], v[64:67], v[48:51]
  v_mfma_f32_16x16x32_bf16 v[48:51], v[180:183], v[68:71], v[48:51]
  v_mfma_f32_16x16x32_bf16 v[48:51], v[184:187], v[72:75], v[48:51]
  v_mfma_f32_16x16x32_bf16 v[48:51], v[188:191], v[76:79], v[48:51]
  s_waitcnt vmcnt(12)
  v_mfma_f32_16x16x32_bf16 v[52:55], v[192:195], v[32:35], 0
  v_mfma_f32_16x16x32_bf16 v[58:61], v[200:203], v[32:35], 0
  v_mfma_f32_16x16x32_bf16 v[52:55], v[196:199], v[36:39], v[52:55]
  v_mfma_f32_16x16x32_bf16 v[58:61], v[204:207], v[36:39], v[58:61]
  s_nop 7
  v_permlane32_swap_b32 v52, v58
  v_permlane32_swap_b32 v53, v59
  v_permlane32_swap_b32 v54, v60
  v_permlane32_swap_b32 v55, v61
  v_mov_b32_dpp v58, v58 quad_perm:[1,1,3,3] row_mask:0xf bank_mask:0xf
  v_mov_b32_dpp v59, v59 quad_perm:[1,1,3,3] row_mask:0xf bank_mask:0xf
  v_mov_b32_dpp v60, v60 quad_perm:[1,1,3,3] row_mask:0xf bank_mask:0xf
  v_mov_b32_dpp v61, v61 quad_perm:[1,1,3,3] row_mask:0xf bank_mask:0xf
  v_add_f32_dpp v52, v52, v58 quad_perm:[0,0,2,2] row_mask:0xf bank_mask:0xf
  v_add_f32_dpp v53, v53, v59 quad_perm:[0,0,2,2] row_mask:0xf bank_mask:0xf
  v_add_f32_dpp v54, v54, v60 quad_perm:[0,0,2,2] row_mask:0xf bank_mask:0xf
  v_add_f32_dpp v55, v55, v61 quad_perm:[0,0,2,2] row_mask:0xf bank_mask:0xf
  v_max3_f32 v56, v52, v53, v54
  v_max_f32 v56, v56, v55
  v_mov_b32 v57, v56
  s_nop 1
  v_permlane16_swap_b32 v56, v57
  v_max_f32 v56, v56, v57
  v_mov_b32 v57, v56
  s_nop 1
  v_permlane32_swap_b32 v56, v57
  v_max_f32 v56, v56, v57
  v_mul_f32 v56, s59, v56
  v_max_f32 v56, v56, v80
  v_sub_f32 v57, v80, v56
  v_mov_b32 v80, v56
  v_exp_f32 v57, v57
  v_fma_f32 v58, v52, s59, -v56
  v_fma_f32 v59, v53, s59, -v56
  v_fma_f32 v60, v54, s59, -v56
  v_fma_f32 v61, v55, s59, -v56
  v_exp_f32 v58, v58
  v_exp_f32 v59, v59
  v_exp_f32 v60, v60
  v_exp_f32 v61, v61
  v_mul_f32 v48, v48, v57
  v_mul_f32 v49, v49, v57
  v_mul_f32 v50, v50, v57
  v_mul_f32 v51, v51, v57
  v_cvt_pk_bf16_f32 v62, v58, v59
  v_cvt_pk_bf16_f32 v63, v60, v61
  v_add_f32 v58, v58, v59
  v_add_f32 v60, v60, v61
  v_add_f32 v58, v58, v60
  v_fma_f32 v81, v81, v57, v58
  v_perm_b32 v64, v62, v62, v8
  v_perm_b32 v65, v62, v62, v9
  v_perm_b32 v66, v62, v62, v10
  v_perm_b32 v67, v62, v62, v11
  v_perm_b32 v68, v62, v62, v12
  v_perm_b32 v69, v62, v62, v13
  v_perm_b32 v70, v62, v62, v14
  v_perm_b32 v71, v62, v62, v15
  v_perm_b32 v72, v63, v63, v8
  v_perm_b32 v73, v63, v63, v9
  v_perm_b32 v74, v63, v63, v10
  v_perm_b32 v75, v63, v63, v11
  v_perm_b32 v76, v63, v63, v12
  v_perm_b32 v77, v63, v63, v13
  v_perm_b32 v78, v63, v63, v14
  v_perm_b32 v79, v63, v63, v15
  s_waitcnt vmcnt(8)
  v_mfma_f32_16x16x32_bf16 v[48:51], v[208:211], v[64:67], v[48:51]
  v_mfma_f32_16x16x32_bf16 v[48:51], v[212:215], v[68:71], v[48:51]
  v_mfma_f32_16x16x32_bf16 v[48:51], v[216:219], v[72:75], v[48:51]
  v_mfma_f32_16x16x32_bf16 v[48:51], v[220:223], v[76:79], v[48:51]
  s_waitcnt vmcnt(4)
  v_mfma_f32_16x16x32_bf16 v[52:55], v[224:227], v[32:35], 0
  v_mfma_f32_16x16x32_bf16 v[58:61], v[232:235], v[32:35], 0
  v_mfma_f32_16x16x32_bf16 v[52:55], v[228:231], v[36:39], v[52:55]
  v_mfma_f32_16x16x32_bf16 v[58:61], v[236:239], v[36:39], v[58:61]
  s_nop 7
  v_permlane32_swap_b32 v52, v58
  v_permlane32_swap_b32 v53, v59
  v_permlane32_swap_b32 v54, v60
  v_permlane32_swap_b32 v55, v61
  v_mov_b32_dpp v58, v58 quad_perm:[1,1,3,3] row_mask:0xf bank_mask:0xf
  v_mov_b32_dpp v59, v59 quad_perm:[1,1,3,3] row_mask:0xf bank_mask:0xf
  v_mov_b32_dpp v60, v60 quad_perm:[1,1,3,3] row_mask:0xf bank_mask:0xf
  v_mov_b32_dpp v61, v61 quad_perm:[1,1,3,3] row_mask:0xf bank_mask:0xf
  v_add_f32_dpp v52, v52, v58 quad_perm:[0,0,2,2] row_mask:0xf bank_mask:0xf
  v_add_f32_dpp v53, v53, v59 quad_perm:[0,0,2,2] row_mask:0xf bank_mask:0xf
  v_add_f32_dpp v54, v54, v60 quad_perm:[0,0,2,2] row_mask:0xf bank_mask:0xf
  v_add_f32_dpp v55, v55, v61 quad_perm:[0,0,2,2] row_mask:0xf bank_mask:0xf
  v_max3_f32 v56, v52, v53, v54
  v_max_f32 v56, v56, v55
  v_mov_b32 v57, v56
  s_nop 1
  v_permlane16_swap_b32 v56, v57
  v_max_f32 v56, v56, v57
  v_mov_b32 v57, v56
  s_nop 1
  v_permlane32_swap_b32 v56, v57
  v_max_f32 v56, v56, v57
  v_mul_f32 v56, s59, v56
  v_max_f32 v56, v56, v80
  v_sub_f32 v57, v80, v56
  v_mov_b32 v80, v56
  v_exp_f32 v57, v57
  v_fma_f32 v58, v52, s59, -v56
  v_fma_f32 v59, v53, s59, -v56
  v_fma_f32 v60, v54, s59, -v56
  v_fma_f32 v61, v55, s59, -v56
  v_exp_f32 v58, v58
  v_exp_f32 v59, v59
  v_exp_f32 v60, v60
  v_exp_f32 v61, v61
  v_mul_f32 v48, v48, v57
  v_mul_f32 v49, v49, v57
  v_mul_f32 v50, v50, v57
  v_mul_f32 v51, v51, v57
  v_cvt_pk_bf16_f32 v62, v58, v59
  v_cvt_pk_bf16_f32 v63, v60, v61
  v_add_f32 v58, v58, v59
  v_add_f32 v60, v60, v61
  v_add_f32 v58, v58, v60
  v_fma_f32 v81, v81, v57, v58
  v_perm_b32 v64, v62, v62, v8
  v_perm_b32 v65, v62, v62, v9
  v_perm_b32 v66, v62, v62, v10
  v_perm_b32 v67, v62, v62, v11
  v_perm_b32 v68, v62, v62, v12
  v_perm_b32 v69, v62, v62, v13
  v_perm_b32 v70, v62, v62, v14
  v_perm_b32 v71, v62, v62, v15
  v_perm_b32 v72, v63, v63, v8
  v_perm_b32 v73, v63, v63, v9
  v_perm_b32 v74, v63, v63, v10
  v_perm_b32 v75, v63, v63, v11
  v_perm_b32 v76, v63, v63, v12
  v_perm_b32 v77, v63, v63, v13
  v_perm_b32 v78, v63, v63, v14
  v_perm_b32 v79, v63, v63, v15
  s_waitcnt vmcnt(0)
  v_mfma_f32_16x16x32_bf16 v[48:51], v[240:243], v[64:67], v[48:51]
  v_mfma_f32_16x16x32_bf16 v[48:51], v[244:247], v[68:71], v[48:51]
  v_mfma_f32_16x16x32_bf16 v[48:51], v[248:251], v[72:75], v[48:51]
  v_mfma_f32_16x16x32_bf16 v[48:51], v[252:255], v[76:79], v[48:51]
  s_nop 6
  s_setpc_b64 s[62:63]
L_bodyA0:
  s_waitcnt vmcnt(28)
  v_mfma_f32_16x16x32_bf16 v[52:55], a[0:3], v[32:35], 0
  v_mfma_f32_16x16x32_bf16 v[58:61], a[8:11], v[32:35], 0
  v_mfma_f32_16x16x32_bf16 v[52:55], a[4:7], v[36:39], v[52:55]
  v_mfma_f32_16x16x32_bf16 v[58:61], a[12:15], v[36:39], v[58:61]
  s_nop 7
  v_permlane32_swap_b32 v52, v58
  v_permlane32_swap_b32 v53, v59
  v_permlane32_swap_b32 v54, v60
  v_permlane32_swap_b32 v55, v61
  v_mov_b32_dpp v58, v58 quad_perm:[1,1,3,3] row_mask:0xf bank_mask:0xf
  v_mov_b32_dpp v59, v59 quad_perm:[1,1,3,3] row_mask:0xf bank_mask:0xf
  v_mov_b32_dpp v60, v60 quad_perm:[1,1,3,3] row_mask:0xf bank_mask:0xf
  v_mov_b32_dpp v61, v61 quad_perm:[1,1,3,3] row_mask:0xf bank_mask:0xf
  v_add_f32_dpp v52, v52, v58 quad_perm:[0,0,2,2] row_mask:0xf bank_mask:0xf
  v_add_f32_dpp v53, v53, v59 quad_perm:[0,0,2,2] row_mask:0xf bank_mask:0xf
  v_add_f32_dpp v54, v54, v60 quad_perm:[0,0,2,2] row_mask:0xf bank_mask:0xf
  v_add_f32_dpp v55, v55, v61 quad_perm:[0,0,2,2] row_mask:0xf bank_mask:0xf
  v_max3_f32 v56, v52, v53, v54
  v_max_f32 v56, v56, v55
  v_mov_b32 v57, v56
  s_nop 1
  v_permlane16_swap_b32 v56, v57
  v_max_f32 v56, v56, v57
  v_mov_b32 v57, v56
  s_nop 1
  v_permlane32_swap_b32 v56, v57
  v_max_f32 v56, v56, v57
  v_mul_f32 v56, s59, v56
  v_max_f32 v56, v56, v80
  v_sub_f32 v57, v80, v56
  v_mov_b32 v80, v56
  v_exp_f32 v57, v57
  v_fma_f32 v58, v52, s59, -v56
  v_fma_f32 v59, v53, s59, -v56
  v_fma_f32 v60, v54, s59, -v56
  v_fma_f32 v61, v55, s59, -v56
  v_exp_f32 v58, v58
  v_exp_f32 v59, v59
  v_exp_f32 v60, v60
  v_exp_f32 v61, v61
  v_mul_f32 v48, v48, v57
  v_mul_f32 v49, v49, v57
  v_mul_f32 v50, v50, v57
  v_mul_f32 v51, v51, v57
  v_cvt_pk_bf16_f32 v62, v58, v59
  v_cvt_pk_bf16_f32 v63, v60, v61
  v_add_f32 v58, v58, v59
  v_add_f32 v60, v60, v61
  v_add_f32 v58, v58, v60
  v_fma_f32 v81, v81, v57, v58
  v_perm_b32 v64, v62, v62, v8
  v_perm_b32 v65, v62, v62, v9
  v_perm_b32 v66, v62, v62, v10
  v_perm_b32 v67, v62, v62, v11
  v_perm_b32 v68, v62, v62, v12
  v_perm_b32 v69, v62, v62, v13
  v_perm_b32 v70, v62, v62, v14
  v_perm_b32 v71, v62, v62, v15
  v_perm_b32 v72, v63, v63, v8
  v_perm_b32 v73, v63, v63, v9
  v_perm_b32 v74, v63, v63, v10
  v_perm_b32 v75, v63, v63, v11
  v_perm_b32 v76, v63, v63, v12
  v_perm_b32 v77, v63, v63, v13
  v_perm_b32 v78, v63, v63, v14
  v_perm_b32 v79, v63, v63, v15
  s_waitcnt vmcnt(28)
  v_mfma_f32_16x16x32_bf16 v[48:51], a[16:19], v[64:67], v[48:51]
  v_mfma_f32_16x16x32_bf16 v[48:51], a[20:23], v[68:71], v[48:51]
  v_mfma_f32_16x16x32_bf16 v[48:51], a[24:27], v[72:75], v[48:51]
  v_mfma_f32_16x16x32_bf16 v[48:51], a[28:31], v[76:79], v[48:51]
  s_waitcnt vmcnt(28)
  v_mfma_f32_16x16x32_bf16 v[52:55], a[32:35], v[32:35], 0
  v_mfma_f32_16x16x32_bf16 v[58:61], a[40:43], v[32:35], 0
  v_mfma_f32_16x16x32_bf16 v[52:55], a[36:39], v[36:39], v[52:55]
  v_mfma_f32_16x16x32_bf16 v[58:61], a[44:47], v[36:39], v[58:61]
  s_nop 7
  v_permlane32_swap_b32 v52, v58
  v_permlane32_swap_b32 v53, v59
  v_permlane32_swap_b32 v54, v60
  v_permlane32_swap_b32 v55, v61
  v_mov_b32_dpp v58, v58 quad_perm:[1,1,3,3] row_mask:0xf bank_mask:0xf
  v_mov_b32_dpp v59, v59 quad_perm:[1,1,3,3] row_mask:0xf bank_mask:0xf
  v_mov_b32_dpp v60, v60 quad_perm:[1,1,3,3] row_mask:0xf bank_mask:0xf
  v_mov_b32_dpp v61, v61 quad_perm:[1,1,3,3] row_mask:0xf bank_mask:0xf
  v_add_f32_dpp v52, v52, v58 quad_perm:[0,0,2,2] row_mask:0xf bank_mask:0xf
  v_add_f32_dpp v53, v53, v59 quad_perm:[0,0,2,2] row_mask:0xf bank_mask:0xf
  v_add_f32_dpp v54, v54, v60 quad_perm:[0,0,2,2] row_mask:0xf bank_mask:0xf
  v_add_f32_dpp v55, v55, v61 quad_perm:[0,0,2,2] row_mask:0xf bank_mask:0xf
  v_max3_f32 v56, v52, v53, v54
  v_max_f32 v56, v56, v55
  v_mov_b32 v57, v56
  s_nop 1
  v_permlane16_swap_b32 v56, v57
  v_max_f32 v56, v56, v57
  v_mov_b32 v57, v56
  s_nop 1
  v_permlane32_swap_b32 v56, v57
  v_max_f32 v56, v56, v57
  v_mul_f32 v56, s59, v56
  v_max_f32 v56, v56, v80
  v_sub_f32 v57, v80, v56
  v_mov_b32 v80, v56
  v_exp_f32 v57, v57
  v_fma_f32 v58, v52, s59, -v56
  v_fma_f32 v59, v53, s59, -v56
  v_fma_f32 v60, v54, s59, -v56
  v_fma_f32 v61, v55, s59, -v56
  v_exp_f32 v58, v58
  v_exp_f32 v59, v59
  v_exp_f32 v60, v60
  v_exp_f32 v61, v61
  v_mul_f32 v48, v48, v57
  v_mul_f32 v49, v49, v57
  v_mul_f32 v50, v50, v57
  v_mul_f32 v51, v51, v57
  v_cvt_pk_bf16_f32 v62, v58, v59
  v_cvt_pk_bf16_f32 v63, v60, v61
  v_add_f32 v58, v58, v59
  v_add_f32 v60, v60, v61
  v_add_f32 v58, v58, v60
  v_fma_f32 v81, v81, v57, v58
  v_perm_b32 v64, v62, v62, v8
  v_perm_b32 v65, v62, v62, v9
  v_perm_b32 v66, v62, v62, v10
  v_perm_b32 v67, v62, v62, v11
  v_perm_b32 v68, v62, v62, v12
  v_perm_b32 v69, v62, v62, v13
  v_perm_b32 v70, v62, v62, v14
  v_perm_b32 v71, v62, v62, v15
  v_perm_b32 v72, v63, v63, v8
  v_perm_b32 v73, v63, v63, v9
  v_perm_b32 v74, v63, v63, v10
  v_perm_b32 v75, v63, v63, v11
  v_perm_b32 v76, v63, v63, v12
  v_perm_b32 v77, v63, v63, v13
  v_perm_b32 v78, v63, v63, v14
  v_perm_b32 v79, v63, v63, v15
  s_waitcnt vmcnt(28)
  v_mfma_f32_16x16x32_bf16 v[48:51], a[48:51], v[64:67], v[48:51]
  v_mfma_f32_16x16x32_bf16 v[48:51], a[52:55], v[68:71], v[48:51]
  v_mfma_f32_16x16x32_bf16 v[48:51], a[56:59], v[72:75], v[48:51]
  v_mfma_f32_16x16x32_bf16 v[48:51], a[60:63], v[76:79], v[48:51]
  s_waitcnt vmcnt(28)
  v_mfma_f32_16x16x32_bf16 v[52:55], a[64:67], v[32:35], 0
  v_mfma_f32_16x16x32_bf16 v[58:61], a[72:75], v[32:35], 0
  v_mfma_f32_16x16x32_bf16 v[52:55], a[68:71], v[36:39], v[52:55]
  v_mfma_f32_16x16x32_bf16 v[58:61], a[76:79], v[36:39], v[58:61]
  s_nop 7
  v_permlane32_swap_b32 v52, v58
  v_permlane32_swap_b32 v53, v59
  v_permlane32_swap_b32 v54, v60
  v_permlane32_swap_b32 v55, v61
  v_mov_b32_dpp v58, v58 quad_perm:[1,1,3,3] row_mask:0xf bank_mask:0xf
  v_mov_b32_dpp v59, v59 quad_perm:[1,1,3,3] row_mask:0xf bank_mask:0xf
  v_mov_b32_dpp v60, v60 quad_perm:[1,1,3,3] row_mask:0xf bank_mask:0xf
  v_mov_b32_dpp v61, v61 quad_perm:[1,1,3,3] row_mask:0xf bank_mask:0xf
  v_add_f32_dpp v52, v52, v58 quad_perm:[0,0,2,2] row_mask:0xf bank_mask:0xf
  v_add_f32_dpp v53, v53, v59 quad_perm:[0,0,2,2] row_mask:0xf bank_mask:0xf
  v_add_f32_dpp v54, v54, v60 quad_perm:[0,0,2,2] row_mask:0xf bank_mask:0xf
  v_add_f32_dpp v55, v55, v61 quad_perm:[0,0,2,2] row_mask:0xf bank_mask:0xf
  v_max3_f32 v56, v52, v53, v54
  v_max_f32 v56, v56, v55
  v_mov_b32 v57, v56
  s_nop 1
  v_permlane16_swap_b32 v56, v57
  v_max_f32 v56, v56, v57
  v_mov_b32 v57, v56
  s_nop 1
  v_permlane32_swap_b32 v56, v57
  v_max_f32 v56, v56, v57
  v_mul_f32 v56, s59, v56
  v_max_f32 v56, v56, v80
  v_sub_f32 v57, v80, v56
  v_mov_b32 v80, v56
  v_exp_f32 v57, v57
  v_fma_f32 v58, v52, s59, -v56
  v_fma_f32 v59, v53, s59, -v56
  v_fma_f32 v60, v54, s59, -v56
  v_fma_f32 v61, v55, s59, -v56
  v_exp_f32 v58, v58
  v_exp_f32 v59, v59
  v_exp_f32 v60, v60
  v_exp_f32 v61, v61
  v_mul_f32 v48, v48, v57
  v_mul_f32 v49, v49, v57
  v_mul_f32 v50, v50, v57
  v_mul_f32 v51, v51, v57
  v_cvt_pk_bf16_f32 v62, v58, v59
  v_cvt_pk_bf16_f32 v63, v60, v61
  v_add_f32 v58, v58, v59
  v_add_f32 v60, v60, v61
  v_add_f32 v58, v58, v60
  v_fma_f32 v81, v81, v57, v58
  v_perm_b32 v64, v62, v62, v8
  v_perm_b32 v65, v62, v62, v9
  v_perm_b32 v66, v62, v62, v10
  v_perm_b32 v67, v62, v62, v11
  v_perm_b32 v68, v62, v62, v12
  v_perm_b32 v69, v62, v62, v13
  v_perm_b32 v70, v62, v62, v14
  v_perm_b32 v71, v62, v62, v15
  v_perm_b32 v72, v63, v63, v8
  v_perm_b32 v73, v63, v63, v9
  v_perm_b32 v74, v63, v63, v10
  v_perm_b32 v75, v63, v63, v11
  v_perm_b32 v76, v63, v63, v12
  v_perm_b32 v77, v63, v63, v13
  v_perm_b32 v78, v63, v63, v14
  v_perm_b32 v79, v63, v63, v15
  s_waitcnt vmcnt(28)
  v_mfma_f32_16x16x32_bf16 v[48:51], a[80:83], v[64:67], v[48:51]
  v_mfma_f32_16x16x32_bf16 v[48:51], a[84:87], v[68:71], v[48:51]
  v_mfma_f32_16x16x32_bf16 v[48:51], a[88:91], v[72:75], v[48:51]
  v_mfma_f32_16x16x32_bf16 v[48:51], a[92:95], v[76:79], v[48:51]
  s_waitcnt vmcnt(28)
  v_mfma_f32_16x16x32_bf16 v[52:55], a[96:99], v[32:35], 0
  v_mfma_f32_16x16x32_bf16 v[58:61], a[104:107], v[32:35], 0
  v_mfma_f32_16x16x32_bf16 v[52:55], a[100:103], v[36:39], v[52:55]
  v_mfma_f32_16x16x32_bf16 v[58:61], a[108:111], v[36:39], v[58:61]
  s_nop 7
  v_permlane32_swap_b32 v52, v58
  v_permlane32_swap_b32 v53, v59
  v_permlane32_swap_b32 v54, v60
  v_permlane32_swap_b32 v55, v61
  v_mov_b32_dpp v58, v58 quad_perm:[1,1,3,3] row_mask:0xf bank_mask:0xf
  v_mov_b32_dpp v59, v59 quad_perm:[1,1,3,3] row_mask:0xf bank_mask:0xf
  v_mov_b32_dpp v60, v60 quad_perm:[1,1,3,3] row_mask:0xf bank_mask:0xf
  v_mov_b32_dpp v61, v61 quad_perm:[1,1,3,3] row_mask:0xf bank_mask:0xf
  v_add_f32_dpp v52, v52, v58 quad_perm:[0,0,2,2] row_mask:0xf bank_mask:0xf
  v_add_f32_dpp v53, v53, v59 quad_perm:[0,0,2,2] row_mask:0xf bank_mask:0xf
  v_add_f32_dpp v54, v54, v60 quad_perm:[0,0,2,2] row_mask:0xf bank_mask:0xf
  v_add_f32_dpp v55, v55, v61 quad_perm:[0,0,2,2] row_mask:0xf bank_mask:0xf
  v_max3_f32 v56, v52, v53, v54
  v_max_f32 v56, v56, v55
  v_mov_b32 v57, v56
  s_nop 1
  v_permlane16_swap_b32 v56, v57
  v_max_f32 v56, v56, v57
  v_mov_b32 v57, v56
  s_nop 1
  v_permlane32_swap_b32 v56, v57
  v_max_f32 v56, v56, v57
  v_mul_f32 v56, s59, v56
  v_max_f32 v56, v56, v80
  v_sub_f32 v57, v80, v56
  v_mov_b32 v80, v56
  v_exp_f32 v57, v57
  v_fma_f32 v58, v52, s59, -v56
  v_fma_f32 v59, v53, s59, -v56
  v_fma_f32 v60, v54, s59, -v56
  v_fma_f32 v61, v55, s59, -v56
  v_exp_f32 v58, v58
  v_exp_f32 v59, v59
  v_exp_f32 v60, v60
  v_exp_f32 v61, v61
  v_mul_f32 v48, v48, v57
  v_mul_f32 v49, v49, v57
  v_mul_f32 v50, v50, v57
  v_mul_f32 v51, v51, v57
  v_cvt_pk_bf16_f32 v62, v58, v59
  v_cvt_pk_bf16_f32 v63, v60, v61
  v_add_f32 v58, v58, v59
  v_add_f32 v60, v60, v61
  v_add_f32 v58, v58, v60
  v_fma_f32 v81, v81, v57, v58
  v_perm_b32 v64, v62, v62, v8
  v_perm_b32 v65, v62, v62, v9
  v_perm_b32 v66, v62, v62, v10
  v_perm_b32 v67, v62, v62, v11
  v_perm_b32 v68, v62, v62, v12
  v_perm_b32 v69, v62, v62, v13
  v_perm_b32 v70, v62, v62, v14
  v_perm_b32 v71, v62, v62, v15
  v_perm_b32 v72, v63, v63, v8
  v_perm_b32 v73, v63, v63, v9
  v_perm_b32 v74, v63, v63, v10
  v_perm_b32 v75, v63, v63, v11
  v_perm_b32 v76, v63, v63, v12
  v_perm_b32 v77, v63, v63, v13
  v_perm_b32 v78, v63, v63, v14
  v_perm_b32 v79, v63, v63, v15
  s_waitcnt vmcnt(28)
  v_mfma_f32_16x16x32_bf16 v[48:51], a[112:115], v[64:67], v[48:51]
  v_mfma_f32_16x16x32_bf16 v[48:51], a[116:119], v[68:71], v[48:51]
  v_mfma_f32_16x16x32_bf16 v[48:51], a[120:123], v[72:75], v[48:51]
  v_mfma_f32_16x16x32_bf16 v[48:51], a[124:127], v[76:79], v[48:51]
  s_nop 6
  s_setpc_b64 s[62:63]
.section .rodata,"a"
.p2align 6
.amdhsa_kernel standalone__mha_block_cached__sampling_kernel
  .amdhsa_next_free_vgpr 512
  .amdhsa_next_free_sgpr 102
  .amdhsa_accum_offset 256
  .amdhsa_group_segment_fixed_size 0
  .amdhsa_kernarg_size 64
  .amdhsa_user_sgpr_count 2
  .amdhsa_user_sgpr_kernarg_segment_ptr 1
  .amdhsa_system_sgpr_workgroup_id_x 1
.end_amdhsa_kernel
```
